```python
import torch

def _softmax(x, axis=-1):
    return torch.softmax(x, dim=axis)
def _gelu(x):
    return torch.nn.functional.gelu(x, approximate="tanh")
def _silu(x):
    return torch.nn.functional.silu(x)
def _sigmoid(x):
    return torch.sigmoid(x)
def _layernorm(x, axis=-1, eps=1e-5):
    m = x.mean(dim=axis, keepdim=True)
    v = x.var(dim=axis, keepdim=True, unbiased=False)
    return (x - m) / torch.sqrt(v + eps)
def _scatter_add(tgt, idx, src, axis=0):
    return tgt.clone().index_add_(axis, idx, src)
def _segment_sum(src, seg, n):
    out = torch.zeros((n,) + src.shape[1:], dtype=src.dtype)
    return out.index_add_(0, seg, src)
def _pad(x, pw):
    flat = tuple(v for pair in reversed(pw) for v in pair)
    return torch.nn.functional.pad(x, flat)

kernel_name = 'gated_mix__sliding_block__mixer_s_mlp__prompt'

def setup_inputs():

    _w = (lambda a: (lambda t: t.to(torch.bfloat16) if t.is_floating_point() else t)(torch.as_tensor(a)))
    def _A_setup():
        B, S, D = 1, 2048, 448
        return {
            "x": _w((lambda *s: torch.randn(*s, dtype=torch.bfloat16) * 0.05)(B, S, D)),
            "wqkv": _w((lambda *s: torch.randn(*s, dtype=torch.bfloat16) * 3.2)(D, 3 * D)),
            "wo": _w((lambda *s: torch.randn(*s, dtype=torch.bfloat16) * 0.05)(D, D)),
        }
    _A_in = _A_setup()

    def _B_setup():
        B, S, D, F = 1, 2048, 448, 1792
        return {
            "x":  _w((lambda *s: torch.randn(*s, dtype=torch.bfloat16) * 0.05)(B, S, D)),
            "w1": _w((lambda *s: torch.randn(*s, dtype=torch.bfloat16) * 3.2)(D, D) * (D ** -0.5)),
            "w2": _w((lambda *s: torch.randn(*s, dtype=torch.bfloat16) * 3.2)(D, D) * (D ** -0.5)),
            "w3": _w((lambda *s: torch.randn(*s, dtype=torch.bfloat16) * 3.2)(D, F) * (D ** -0.5)),
            "w4": _w((lambda *s: torch.randn(*s, dtype=torch.bfloat16) * 3.2)(F, D) * (F ** -0.5)),
        }
    _B_in = _B_setup()

    return {
        "A_x": _A_in["x"],
        "A_wqkv": _A_in["wqkv"],
        "A_wo": _A_in["wo"],
        "B_x": _B_in["x"],
        "B_w1": _B_in["w1"],
        "B_w2": _B_in["w2"],
        "B_w3": _B_in["w3"],
        "B_w4": _B_in["w4"],
        "gate_w": _w((lambda *s: torch.randn(*s, dtype=torch.bfloat16) * 0.05)(448) * 16.0),
    }

def reference(A_x, A_wqkv, A_wo, B_x, B_w1, B_w2, B_w3, B_w4, gate_w):
    def _A_ref(x, wqkv, wo):
        B, S, D = x.shape
        H = 16; Dh = D // H; W = 256
        qkv = (lambda x, *d: x.permute(*d))((x @ wqkv).reshape(B, S, 3, H, Dh), 2, 0, 3, 1, 4)
        q, k, v = qkv[0], qkv[1], qkv[2]
        scores = torch.einsum("bhqd,bhkd->bhqk", q, k) * (Dh ** -0.5)
        idx = torch.arange(S)
        mask = (idx[:, None] - idx[None, :] >= 0) & (idx[:, None] - idx[None, :] < W)
        scores = torch.where(mask[None, None], scores, -1e9)
        p = _softmax(scores, axis=-1)
        o = torch.einsum("bhqk,bhkd->bhqd", p, v)
        return (lambda x, *d: x.permute(*d))(o, 0, 2, 1, 3).reshape(B, S, D) @ wo

    def _B_ref(x, w1, w2, w3, w4):
        B, S, D = x.shape
        h = _gelu(_layernorm(x, axis=-1) @ w1)
        c = D // 4
        g0 = _pad(h[:, :, 0*c:1*c], ((0, 0), (1, 0), (0, 0)))[:, :S, :]
        g1 = _pad(h[:, :, 1*c:2*c], ((0, 0), (0, 1), (0, 0)))[:, 1:, :]
        g2 = _pad(h[:, :, 2*c:3*c], ((0, 0), (2, 0), (0, 0)))[:, :S, :]
        g3 = _pad(h[:, :, 3*c:   ], ((0, 0), (0, 2), (0, 0)))[:, 2:, :]
        hs = torch.concatenate([g0, g1, g2, g3], axis=-1) @ w2
        x1 = x + hs
        h2 = _gelu(_layernorm(x1, axis=-1) @ w3) @ w4
        return x1 + h2

    x = A_x
    g = _sigmoid((x * gate_w).sum(-1, keepdims=True))
    a = _A_ref(x, A_wqkv, A_wo)
    b = _B_ref(x, B_w1, B_w2, B_w3, B_w4)
    return g * a + (1 - g) * b
```

```asm
; @launch grid=(256,1,1) block=(512,1,1) lds=163840
.amdgcn_target "amdgcn-amd-amdhsa--gfx950"
.text
.globl gated_mix__sliding_block__mixer_s_mlp__prompt_kernel
.p2align 8
.type gated_mix__sliding_block__mixer_s_mlp__prompt_kernel,@function
gated_mix__sliding_block__mixer_s_mlp__prompt_kernel:
    s_cmp_ge_u32 s2, 256
    s_cbranch_scc1 k_end
    s_load_dwordx4 s[4:7], s[0:1], 0
    s_load_dwordx2 s[8:9], s[0:1], 32
    s_load_dwordx4 s[56:59], s[0:1], 80
    s_memrealtime s[82:83]
    v_and_b32 v1, 63, v0
    v_lshrrev_b32 v2, 6, v0
    s_nop 0
    v_readfirstlane_b32 s19, v2
    v_and_b32 v2, 15, v1
    v_lshrrev_b32 v3, 4, v1
    v_lshlrev_b32 v240, 4, v1
    s_cmp_ge_u32 s2, 224
    s_cbranch_scc1 helper
    s_and_b32 s14, s2, 7
    s_lshr_b32 s15, s2, 3
    s_mul_i32 s16, s15, 9363
    s_lshr_b32 s16, s16, 16
    s_mul_i32 s18, s16, 7
    s_sub_u32 s18, s15, s18
    s_lshr_b32 s17, s14, 1
    s_lshl_b32 s17, s17, 2
    s_add_u32 s17, s17, s16
    s_and_b32 s16, s14, 1
    s_mul_i32 s16, s16, 7
    s_add_u32 s18, s18, s16
    s_and_b32 s40, s19, 3
    s_lshr_b32 s41, s19, 2
    s_lshl_b32 s36, s19, 11
    s_lshl_b32 s37, s41, 13
    s_lshl_b32 s42, s40, 10
    s_add_u32 s37, s37, s42
    s_add_u32 s37, s37, 16384
    s_lshl_b32 s33, s18, 1
    s_add_u32 s33, s33, s41
    s_and_b32 s43, s40, 1
    s_lshl_b32 s43, s43, 2
    s_sub_u32 s46, s33, 21
    s_movk_i32 s32, 896
    s_cmp_lt_u32 s33, 21
    s_cselect_b32 s32, 2688, s32
    s_cselect_b32 s34, s33, s46
    s_lshl_b32 s34, s34, 7
    s_lshl_b32 s35, s40, 3
    s_mul_i32 s35, s35, s32
    s_add_u32 s34, s34, s35
    s_lshl_b32 s38, s32, 5
    v_lshrrev_b32 v24, 3, v1
    v_and_b32 v25, 2, v24
    v_add_u32 v25, s43, v25
    v_xor_b32 v25, v25, v1
    v_and_b32 v25, 7, v25
    v_mul_lo_u32 v6, v24, s32
    v_lshl_add_u32 v6, v25, 4, v6
    v_lshrrev_b32 v24, 3, v1
    v_lshrrev_b32 v25, 1, v24
    v_xor_b32 v25, v25, v1
    v_and_b32 v25, 7, v25
    v_mul_u32_u24 v4, 896, v24
    v_lshl_add_u32 v4, v25, 4, v4
    v_xor_b32 v5, 64, v4
    v_add_u32 v5, 6144, v5
    s_lshl_b32 s35, s17, 3
    s_add_u32 s35, s35, s19
    s_mul_i32 s35, s35, 14336
    s_waitcnt lgkmcnt(0)
    s_mov_b32 s20, s4
    s_and_b32 s21, s5, 0xffff
    s_mov_b32 s22, 1835008
    s_mov_b32 s23, 0x00020000
    s_mov_b32 s26, 401408
    s_cmp_lt_u32 s33, 21
    s_cselect_b32 s24, s6, s8
    s_cselect_b32 s25, s7, s9
    s_cselect_b32 s26, 1204224, s26
    s_and_b32 s25, s25, 0xffff
    s_mov_b32 s27, 0x00020000
    s_add_u32 m0, s36, 0
    s_nop 0
    buffer_load_dwordx4 v4, s[20:23], s35 offen lds
    buffer_load_dwordx4 v5, s[20:23], s35 offen offset:1024 lds
    s_add_u32 s35, s35, 128
    s_add_u32 m0, s37, 0
    s_nop 0
    buffer_load_dwordx4 v6, s[24:27], s34 offen lds
    s_add_u32 s34, s34, s38
    s_add_u32 m0, s37, 4096
    s_nop 0
    buffer_load_dwordx4 v6, s[24:27], s34 offen lds
    s_add_u32 s34, s34, s38
    s_add_u32 m0, s36, 32768
    s_nop 0
    buffer_load_dwordx4 v4, s[20:23], s35 offen lds
    buffer_load_dwordx4 v5, s[20:23], s35 offen offset:1024 lds
    s_add_u32 s35, s35, 128
    s_add_u32 m0, s37, 32768
    s_nop 0
    buffer_load_dwordx4 v6, s[24:27], s34 offen lds
    s_add_u32 s34, s34, s38
    s_add_u32 m0, s37, 36864
    s_nop 0
    buffer_load_dwordx4 v6, s[24:27], s34 offen lds
    s_add_u32 s34, s34, s38
    s_mov_b32 s28, s58
    s_and_b32 s29, s59, 0xffff
    s_mov_b32 s30, 33554432
    s_mov_b32 s31, 0x00020000
    s_getpc_b64 s[60:61]
k_pc:
    s_lshr_b32 s70, s2, 3
    s_lshl_b32 s70, s70, 3
    s_add_u32 s70, s70, s19
    s_lshl_b32 s70, s70, 10
    s_cmp_ge_u32 s70, k_codeend-k_pc
    s_cbranch_scc1 pfc_1
    v_add_u32 v204, s70, v240
    global_load_dwordx4 v[208:211], v204, s[60:61]
pfc_1:
    v_lshrrev_b32 v24, 1, v2
    v_xor_b32 v24, v24, v3
    v_lshlrev_b32 v24, 4, v24
    v_lshl_add_u32 v24, v2, 7, v24
    s_lshl_b32 s42, s40, 12
    v_add_u32 v7, s42, v24
    v_xor_b32 v9, 64, v7
    v_add_u32 v8, 65536, v7
    v_add_u32 v10, 65536, v9
    v_lshrrev_b32 v24, 2, v2
    v_lshl_add_u32 v25, v3, 3, v24
    v_lshlrev_b32 v25, 7, v25
    v_and_b32 v24, 2, v24
    v_and_b32 v26, 1, v3
    v_lshl_add_u32 v24, v26, 2, v24
    v_and_b32 v26, 3, v2
    v_xor_b32 v24, v24, v26
    v_lshl_add_u32 v236, v24, 4, v25
    v_xor_b32 v238, 64, v236
    v_lshrrev_b32 v26, 1, v26
    v_lshlrev_b32 v26, 3, v26
    v_xor_b32 v24, 8, v26
    v_add_u32 v237, v236, v24
    v_add_u32 v239, v238, v24
    v_add_u32 v236, v236, v26
    v_add_u32 v238, v238, v26
    v_lshrrev_b32 v24, 3, v1
    v_and_b32 v25, 2, v24
    v_add_u32 v25, 0, v25
    v_xor_b32 v25, v25, v1
    v_and_b32 v25, 7, v25
    v_mul_u32_u24 v241, 896, v24
    v_lshl_add_u32 v241, v25, 4, v241
    v_lshrrev_b32 v24, 3, v1
    v_and_b32 v25, 2, v24
    v_add_u32 v25, 0, v25
    v_xor_b32 v25, v25, v1
    v_and_b32 v25, 7, v25
    v_xor_b32 v24, 4, v24
    v_mul_u32_u24 v242, 896, v24
    v_lshl_add_u32 v242, v25, 4, v242
    v_lshrrev_b32 v24, 1, v3
    v_lshlrev_b32 v243, 5, v3
    v_lshl_add_u32 v243, v24, 4, v243
    s_lshl_b32 s39, s17, 7
    s_lshl_b32 s42, s40, 5
    s_add_u32 s39, s39, s42
    s_load_dwordx2 s[62:63], s[0:1], 16
    s_load_dwordx4 s[64:67], s[0:1], 40
    s_load_dwordx2 s[68:69], s[0:1], 56
    v_mov_b32 v252, 0
    global_load_dword v200, v252, s[56:57] sc1
    s_sub_u32 s42, s33, 14
    s_cmp_lt_u32 s42, 7
    s_cbranch_scc1 p1_v
    s_lshl_b32 s42, s41, 13
    s_add_u32 s42, s42, 16384
    s_add_u32 s43, s42, 65536
    v_add_u32 v16, s43, v236
    v_add_u32 v12, s42, v236
    v_add_u32 v17, s43, v237
    v_add_u32 v13, s42, v237
    v_add_u32 v18, s43, v238
    v_add_u32 v14, s42, v238
    v_add_u32 v19, s43, v239
    v_add_u32 v15, s42, v239
    s_cmp_ge_u32 s33, 21
    s_cbranch_scc1 p1_w1
    s_waitcnt vmcnt(5)
    s_barrier
    ds_read_b128 v[32:35], v7 offset:0
    ds_read_b128 v[36:39], v7 offset:2048
    ds_read_b64_tr_b16 v[48:49], v12 offset:0
    ds_read_b64_tr_b16 v[50:51], v12 offset:512
    ds_read_b64_tr_b16 v[52:53], v13 offset:0
    ds_read_b64_tr_b16 v[54:55], v13 offset:512
    ds_read_b64_tr_b16 v[56:57], v14 offset:0
    ds_read_b64_tr_b16 v[58:59], v14 offset:512
    ds_read_b64_tr_b16 v[60:61], v15 offset:0
    ds_read_b64_tr_b16 v[62:63], v15 offset:512
    s_waitcnt lgkmcnt(0)
    v_mfma_f32_16x16x32_bf16 v[92:95], v[48:51], v[32:35], 0
    ds_read_b128 v[40:43], v9 offset:0
    ds_read_b128 v[44:47], v9 offset:2048
    ds_read_b64_tr_b16 v[64:65], v12 offset:4096
    v_mfma_f32_16x16x32_bf16 v[108:111], v[48:51], v[36:39], 0
    ds_read_b64_tr_b16 v[66:67], v12 offset:4608
    ds_read_b64_tr_b16 v[68:69], v13 offset:4096
    v_mfma_f32_16x16x32_bf16 v[96:99], v[52:55], v[32:35], 0
    ds_read_b64_tr_b16 v[70:71], v13 offset:4608
    ds_read_b64_tr_b16 v[72:73], v14 offset:4096
    v_mfma_f32_16x16x32_bf16 v[112:115], v[52:55], v[36:39], 0
    ds_read_b64_tr_b16 v[74:75], v14 offset:4608
    ds_read_b64_tr_b16 v[76:77], v15 offset:4096
    v_mfma_f32_16x16x32_bf16 v[100:103], v[56:59], v[32:35], 0
    ds_read_b64_tr_b16 v[78:79], v15 offset:4608
    s_add_u32 m0, s36, 65536
    s_nop 0
    buffer_load_dwordx4 v4, s[20:23], s35 offen lds
    buffer_load_dwordx4 v5, s[20:23], s35 offen offset:1024 lds
    s_add_u32 s35, s35, 128
    v_mfma_f32_16x16x32_bf16 v[116:119], v[56:59], v[36:39], 0
    s_add_u32 m0, s37, 65536
    s_nop 0
    buffer_load_dwordx4 v6, s[24:27], s34 offen lds
    s_add_u32 s34, s34, s38
    s_add_u32 m0, s37, 69632
    s_nop 0
    buffer_load_dwordx4 v6, s[24:27], s34 offen lds
    s_add_u32 s34, s34, s38
    v_mfma_f32_16x16x32_bf16 v[104:107], v[60:63], v[32:35], 0
    v_mfma_f32_16x16x32_bf16 v[120:123], v[60:63], v[36:39], 0
    s_waitcnt vmcnt(5) lgkmcnt(0)
    s_barrier
    v_mfma_f32_16x16x32_bf16 v[92:95], v[64:67], v[40:43], v[92:95]
    ds_read_b128 v[32:35], v7 offset:32768
    ds_read_b128 v[36:39], v7 offset:34816
    ds_read_b64_tr_b16 v[48:49], v12 offset:32768
    v_mfma_f32_16x16x32_bf16 v[108:111], v[64:67], v[44:47], v[108:111]
    ds_read_b64_tr_b16 v[50:51], v12 offset:33280
    ds_read_b64_tr_b16 v[52:53], v13 offset:32768
    v_mfma_f32_16x16x32_bf16 v[96:99], v[68:71], v[40:43], v[96:99]
    ds_read_b64_tr_b16 v[54:55], v13 offset:33280
    ds_read_b64_tr_b16 v[56:57], v14 offset:32768
    v_mfma_f32_16x16x32_bf16 v[112:115], v[68:71], v[44:47], v[112:115]
    ds_read_b64_tr_b16 v[58:59], v14 offset:33280
    ds_read_b64_tr_b16 v[60:61], v15 offset:32768
    v_mfma_f32_16x16x32_bf16 v[100:103], v[72:75], v[40:43], v[100:103]
    ds_read_b64_tr_b16 v[62:63], v15 offset:33280
    s_add_u32 m0, s36, 98304
    s_nop 0
    buffer_load_dwordx4 v4, s[20:23], s35 offen lds
    buffer_load_dwordx4 v5, s[20:23], s35 offen offset:1024 lds
    s_add_u32 s35, s35, 128
    v_mfma_f32_16x16x32_bf16 v[116:119], v[72:75], v[44:47], v[116:119]
    s_add_u32 m0, s37, 98304
    s_nop 0
    buffer_load_dwordx4 v6, s[24:27], s34 offen lds
    s_add_u32 s34, s34, s38
    s_add_u32 m0, s37, 102400
    s_nop 0
    buffer_load_dwordx4 v6, s[24:27], s34 offen lds
    s_add_u32 s34, s34, s38
    v_mfma_f32_16x16x32_bf16 v[104:107], v[76:79], v[40:43], v[104:107]
    v_mfma_f32_16x16x32_bf16 v[120:123], v[76:79], v[44:47], v[120:123]
    s_waitcnt lgkmcnt(0)
    v_mfma_f32_16x16x32_bf16 v[92:95], v[48:51], v[32:35], v[92:95]
    ds_read_b128 v[40:43], v9 offset:32768
    ds_read_b128 v[44:47], v9 offset:34816
    ds_read_b64_tr_b16 v[64:65], v12 offset:36864
    v_mfma_f32_16x16x32_bf16 v[108:111], v[48:51], v[36:39], v[108:111]
    ds_read_b64_tr_b16 v[66:67], v12 offset:37376
    ds_read_b64_tr_b16 v[68:69], v13 offset:36864
    v_mfma_f32_16x16x32_bf16 v[96:99], v[52:55], v[32:35], v[96:99]
    ds_read_b64_tr_b16 v[70:71], v13 offset:37376
    ds_read_b64_tr_b16 v[72:73], v14 offset:36864
    v_mfma_f32_16x16x32_bf16 v[112:115], v[52:55], v[36:39], v[112:115]
    ds_read_b64_tr_b16 v[74:75], v14 offset:37376
    ds_read_b64_tr_b16 v[76:77], v15 offset:36864
    v_mfma_f32_16x16x32_bf16 v[100:103], v[56:59], v[32:35], v[100:103]
    ds_read_b64_tr_b16 v[78:79], v15 offset:37376
    s_add_u32 m0, s36, 0
    s_nop 0
    buffer_load_dwordx4 v4, s[20:23], s35 offen lds
    buffer_load_dwordx4 v5, s[20:23], s35 offen offset:1024 lds
    s_add_u32 s35, s35, 128
    v_mfma_f32_16x16x32_bf16 v[116:119], v[56:59], v[36:39], v[116:119]
    s_add_u32 m0, s37, 0
    s_nop 0
    buffer_load_dwordx4 v6, s[24:27], s34 offen lds
    s_add_u32 s34, s34, s38
    s_add_u32 m0, s37, 4096
    s_nop 0
    buffer_load_dwordx4 v6, s[24:27], s34 offen lds
    s_add_u32 s34, s34, s38
    v_mfma_f32_16x16x32_bf16 v[104:107], v[60:63], v[32:35], v[104:107]
    v_mfma_f32_16x16x32_bf16 v[120:123], v[60:63], v[36:39], v[120:123]
    s_waitcnt vmcnt(8) lgkmcnt(0)
    s_barrier
    v_mfma_f32_16x16x32_bf16 v[92:95], v[64:67], v[40:43], v[92:95]
    ds_read_b128 v[32:35], v8 offset:0
    ds_read_b128 v[36:39], v8 offset:2048
    v_mfma_f32_16x16x32_bf16 v[108:111], v[64:67], v[44:47], v[108:111]
    ds_read_b64_tr_b16 v[48:49], v16 offset:0
    ds_read_b64_tr_b16 v[50:51], v16 offset:512
    v_mfma_f32_16x16x32_bf16 v[96:99], v[68:71], v[40:43], v[96:99]
    ds_read_b64_tr_b16 v[52:53], v17 offset:0
    ds_read_b64_tr_b16 v[54:55], v17 offset:512
    v_mfma_f32_16x16x32_bf16 v[112:115], v[68:71], v[44:47], v[112:115]
    ds_read_b64_tr_b16 v[56:57], v18 offset:0
    ds_read_b64_tr_b16 v[58:59], v18 offset:512
    v_mfma_f32_16x16x32_bf16 v[100:103], v[72:75], v[40:43], v[100:103]
    ds_read_b64_tr_b16 v[60:61], v19 offset:0
    v_mfma_f32_16x16x32_bf16 v[116:119], v[72:75], v[44:47], v[116:119]
    ds_read_b64_tr_b16 v[62:63], v19 offset:512
    v_mfma_f32_16x16x32_bf16 v[104:107], v[76:79], v[40:43], v[104:107]
    v_mfma_f32_16x16x32_bf16 v[120:123], v[76:79], v[44:47], v[120:123]
    s_waitcnt lgkmcnt(0)
    v_mfma_f32_16x16x32_bf16 v[92:95], v[48:51], v[32:35], v[92:95]
    ds_read_b128 v[40:43], v10 offset:0
    ds_read_b128 v[44:47], v10 offset:2048
    ds_read_b64_tr_b16 v[64:65], v16 offset:4096
    v_mfma_f32_16x16x32_bf16 v[108:111], v[48:51], v[36:39], v[108:111]
    ds_read_b64_tr_b16 v[66:67], v16 offset:4608
    ds_read_b64_tr_b16 v[68:69], v17 offset:4096
    v_mfma_f32_16x16x32_bf16 v[96:99], v[52:55], v[32:35], v[96:99]
    ds_read_b64_tr_b16 v[70:71], v17 offset:4608
    ds_read_b64_tr_b16 v[72:73], v18 offset:4096
    v_mfma_f32_16x16x32_bf16 v[112:115], v[52:55], v[36:39], v[112:115]
    ds_read_b64_tr_b16 v[74:75], v18 offset:4608
    ds_read_b64_tr_b16 v[76:77], v19 offset:4096
    v_mfma_f32_16x16x32_bf16 v[100:103], v[56:59], v[32:35], v[100:103]
    ds_read_b64_tr_b16 v[78:79], v19 offset:4608
    s_add_u32 m0, s36, 32768
    s_nop 0
    buffer_load_dwordx4 v4, s[20:23], s35 offen lds
    buffer_load_dwordx4 v5, s[20:23], s35 offen offset:1024 lds
    s_add_u32 s35, s35, 128
    v_mfma_f32_16x16x32_bf16 v[116:119], v[56:59], v[36:39], v[116:119]
    s_add_u32 m0, s37, 32768
    s_nop 0
    buffer_load_dwordx4 v6, s[24:27], s34 offen lds
    s_add_u32 s34, s34, s38
    s_add_u32 m0, s37, 36864
    s_nop 0
    buffer_load_dwordx4 v6, s[24:27], s34 offen lds
    s_add_u32 s34, s34, s38
    v_mfma_f32_16x16x32_bf16 v[104:107], v[60:63], v[32:35], v[104:107]
    v_mfma_f32_16x16x32_bf16 v[120:123], v[60:63], v[36:39], v[120:123]
    s_waitcnt vmcnt(8) lgkmcnt(0)
    s_barrier
    v_mfma_f32_16x16x32_bf16 v[92:95], v[64:67], v[40:43], v[92:95]
    ds_read_b128 v[32:35], v8 offset:32768
    ds_read_b128 v[36:39], v8 offset:34816
    v_mfma_f32_16x16x32_bf16 v[108:111], v[64:67], v[44:47], v[108:111]
    ds_read_b64_tr_b16 v[48:49], v16 offset:32768
    ds_read_b64_tr_b16 v[50:51], v16 offset:33280
    v_mfma_f32_16x16x32_bf16 v[96:99], v[68:71], v[40:43], v[96:99]
    ds_read_b64_tr_b16 v[52:53], v17 offset:32768
    ds_read_b64_tr_b16 v[54:55], v17 offset:33280
    v_mfma_f32_16x16x32_bf16 v[112:115], v[68:71], v[44:47], v[112:115]
    ds_read_b64_tr_b16 v[56:57], v18 offset:32768
    ds_read_b64_tr_b16 v[58:59], v18 offset:33280
    v_mfma_f32_16x16x32_bf16 v[100:103], v[72:75], v[40:43], v[100:103]
    ds_read_b64_tr_b16 v[60:61], v19 offset:32768
    v_mfma_f32_16x16x32_bf16 v[116:119], v[72:75], v[44:47], v[116:119]
    ds_read_b64_tr_b16 v[62:63], v19 offset:33280
    v_mfma_f32_16x16x32_bf16 v[104:107], v[76:79], v[40:43], v[104:107]
    v_mfma_f32_16x16x32_bf16 v[120:123], v[76:79], v[44:47], v[120:123]
    s_waitcnt lgkmcnt(0)
    v_mfma_f32_16x16x32_bf16 v[92:95], v[48:51], v[32:35], v[92:95]
    ds_read_b128 v[40:43], v10 offset:32768
    ds_read_b128 v[44:47], v10 offset:34816
    ds_read_b64_tr_b16 v[64:65], v16 offset:36864
    v_mfma_f32_16x16x32_bf16 v[108:111], v[48:51], v[36:39], v[108:111]
    ds_read_b64_tr_b16 v[66:67], v16 offset:37376
    ds_read_b64_tr_b16 v[68:69], v17 offset:36864
    v_mfma_f32_16x16x32_bf16 v[96:99], v[52:55], v[32:35], v[96:99]
    ds_read_b64_tr_b16 v[70:71], v17 offset:37376
    ds_read_b64_tr_b16 v[72:73], v18 offset:36864
    v_mfma_f32_16x16x32_bf16 v[112:115], v[52:55], v[36:39], v[112:115]
    ds_read_b64_tr_b16 v[74:75], v18 offset:37376
    ds_read_b64_tr_b16 v[76:77], v19 offset:36864
    v_mfma_f32_16x16x32_bf16 v[100:103], v[56:59], v[32:35], v[100:103]
    ds_read_b64_tr_b16 v[78:79], v19 offset:37376
    s_add_u32 m0, s36, 65536
    s_nop 0
    buffer_load_dwordx4 v4, s[20:23], s35 offen lds
    buffer_load_dwordx4 v5, s[20:23], s35 offen offset:1024 lds
    s_add_u32 s35, s35, 128
    v_mfma_f32_16x16x32_bf16 v[116:119], v[56:59], v[36:39], v[116:119]
    s_add_u32 m0, s37, 65536
    s_nop 0
    buffer_load_dwordx4 v6, s[24:27], s34 offen lds
    s_add_u32 s34, s34, s38
    s_add_u32 m0, s37, 69632
    s_nop 0
    buffer_load_dwordx4 v6, s[24:27], s34 offen lds
    s_add_u32 s34, s34, s38
    v_mfma_f32_16x16x32_bf16 v[104:107], v[60:63], v[32:35], v[104:107]
    v_mfma_f32_16x16x32_bf16 v[120:123], v[60:63], v[36:39], v[120:123]
    s_waitcnt vmcnt(8) lgkmcnt(0)
    s_barrier
    v_mfma_f32_16x16x32_bf16 v[92:95], v[64:67], v[40:43], v[92:95]
    ds_read_b128 v[32:35], v7 offset:0
    ds_read_b128 v[36:39], v7 offset:2048
    v_mfma_f32_16x16x32_bf16 v[108:111], v[64:67], v[44:47], v[108:111]
    ds_read_b64_tr_b16 v[48:49], v12 offset:0
    ds_read_b64_tr_b16 v[50:51], v12 offset:512
    v_mfma_f32_16x16x32_bf16 v[96:99], v[68:71], v[40:43], v[96:99]
    ds_read_b64_tr_b16 v[52:53], v13 offset:0
    ds_read_b64_tr_b16 v[54:55], v13 offset:512
    v_mfma_f32_16x16x32_bf16 v[112:115], v[68:71], v[44:47], v[112:115]
    ds_read_b64_tr_b16 v[56:57], v14 offset:0
    ds_read_b64_tr_b16 v[58:59], v14 offset:512
    v_mfma_f32_16x16x32_bf16 v[100:103], v[72:75], v[40:43], v[100:103]
    ds_read_b64_tr_b16 v[60:61], v15 offset:0
    ds_read_b64_tr_b16 v[62:63], v15 offset:512
    v_mfma_f32_16x16x32_bf16 v[116:119], v[72:75], v[44:47], v[116:119]
    s_waitcnt vmcnt(20)
    v_readfirstlane_b32 s84, v200
    s_sub_i32 s85, s82, s84
    s_cmp_lt_i32 s85, 1500
    s_cselect_b32 s85, s84, 0
    s_cmp_lg_u32 s85, 0
    s_cbranch_scc1 tk_2
    v_mov_b32 v252, 0
    s_mov_b32 s93, 0
tok_3:
    global_load_dword v253, v252, s[56:57] sc1
    s_add_u32 s93, s93, 1
    s_waitcnt vmcnt(0)
    v_readfirstlane_b32 s84, v253
    s_cmp_ge_u32 s93, 0x4000
    s_cbranch_scc1 tok_4
    s_sub_i32 s85, s82, s84
    s_cmp_lt_i32 s85, 1500
    s_cselect_b32 s85, s84, 0
    s_cmp_lg_u32 s85, 0
    s_cbranch_scc0 tok_3
tok_4:
tk_2:
    v_mfma_f32_16x16x32_bf16 v[104:107], v[76:79], v[40:43], v[104:107]
    v_mfma_f32_16x16x32_bf16 v[120:123], v[76:79], v[44:47], v[120:123]
    s_waitcnt lgkmcnt(0)
    v_mfma_f32_16x16x32_bf16 v[92:95], v[48:51], v[32:35], v[92:95]
    ds_read_b128 v[40:43], v9 offset:0
    ds_read_b128 v[44:47], v9 offset:2048
    v_mfma_f32_16x16x32_bf16 v[108:111], v[48:51], v[36:39], v[108:111]
    ds_read_b64_tr_b16 v[64:65], v12 offset:4096
    ds_read_b64_tr_b16 v[66:67], v12 offset:4608
    v_mfma_f32_16x16x32_bf16 v[96:99], v[52:55], v[32:35], v[96:99]
    ds_read_b64_tr_b16 v[68:69], v13 offset:4096
    ds_read_b64_tr_b16 v[70:71], v13 offset:4608
    v_mfma_f32_16x16x32_bf16 v[112:115], v[52:55], v[36:39], v[112:115]
    ds_read_b64_tr_b16 v[72:73], v14 offset:4096
    ds_read_b64_tr_b16 v[74:75], v14 offset:4608
    v_mfma_f32_16x16x32_bf16 v[100:103], v[56:59], v[32:35], v[100:103]
    ds_read_b64_tr_b16 v[76:77], v15 offset:4096
    ds_read_b64_tr_b16 v[78:79], v15 offset:4608
    v_mfma_f32_16x16x32_bf16 v[116:119], v[56:59], v[36:39], v[116:119]
    s_lshl_b32 s60, s2, 3
    s_add_u32 s60, s60, s19
    s_lshl_b32 s60, s60, 10
    s_mov_b32 s72, s64
    s_and_b32 s73, s65, 0xffff
    s_mov_b32 s74, 401408
    s_mov_b32 s75, 0x00020000
    s_sub_u32 s61, s60, 0
    buffer_load_dwordx4 v[204:207], v240, s[72:75], s61 offen
    s_mov_b32 s72, s66
    s_and_b32 s73, s67, 0xffff
    s_mov_b32 s74, 1605632
    s_mov_b32 s75, 0x00020000
    s_sub_u32 s61, s60, 0
    buffer_load_dwordx4 v[204:207], v240, s[72:75], s61 offen
    s_mov_b32 s72, s62
    s_and_b32 s73, s63, 0xffff
    s_mov_b32 s74, 401408
    s_mov_b32 s75, 0x00020000
    s_sub_u32 s61, s60, 401408
    buffer_load_dwordx4 v[204:207], v240, s[72:75], s61 offen
    s_mov_b32 s72, s68
    s_and_b32 s73, s69, 0xffff
    s_mov_b32 s74, 1605632
    s_mov_b32 s75, 0x00020000
    s_sub_u32 s61, s60, 229376
    buffer_load_dwordx4 v[204:207], v240, s[72:75], s61 offen
    v_mfma_f32_16x16x32_bf16 v[104:107], v[60:63], v[32:35], v[104:107]
    v_mfma_f32_16x16x32_bf16 v[120:123], v[60:63], v[36:39], v[120:123]
    s_waitcnt vmcnt(8) lgkmcnt(0)
    s_barrier
    v_mfma_f32_16x16x32_bf16 v[92:95], v[64:67], v[40:43], v[92:95]
    ds_read_b128 v[32:35], v7 offset:32768
    ds_read_b128 v[36:39], v7 offset:34816
    v_mfma_f32_16x16x32_bf16 v[108:111], v[64:67], v[44:47], v[108:111]
    ds_read_b64_tr_b16 v[48:49], v12 offset:32768
    ds_read_b64_tr_b16 v[50:51], v12 offset:33280
    v_mfma_f32_16x16x32_bf16 v[96:99], v[68:71], v[40:43], v[96:99]
    ds_read_b64_tr_b16 v[52:53], v13 offset:32768
    ds_read_b64_tr_b16 v[54:55], v13 offset:33280
    v_mfma_f32_16x16x32_bf16 v[112:115], v[68:71], v[44:47], v[112:115]
    ds_read_b64_tr_b16 v[56:57], v14 offset:32768
    ds_read_b64_tr_b16 v[58:59], v14 offset:33280
    v_mfma_f32_16x16x32_bf16 v[100:103], v[72:75], v[40:43], v[100:103]
    ds_read_b64_tr_b16 v[60:61], v15 offset:32768
    v_mfma_f32_16x16x32_bf16 v[116:119], v[72:75], v[44:47], v[116:119]
    ds_read_b64_tr_b16 v[62:63], v15 offset:33280
    v_mfma_f32_16x16x32_bf16 v[104:107], v[76:79], v[40:43], v[104:107]
    v_mfma_f32_16x16x32_bf16 v[120:123], v[76:79], v[44:47], v[120:123]
    s_waitcnt lgkmcnt(0)
    v_mfma_f32_16x16x32_bf16 v[92:95], v[48:51], v[32:35], v[92:95]
    ds_read_b128 v[40:43], v9 offset:32768
    ds_read_b128 v[44:47], v9 offset:34816
    v_mfma_f32_16x16x32_bf16 v[108:111], v[48:51], v[36:39], v[108:111]
    ds_read_b64_tr_b16 v[64:65], v12 offset:36864
    ds_read_b64_tr_b16 v[66:67], v12 offset:37376
    v_mfma_f32_16x16x32_bf16 v[96:99], v[52:55], v[32:35], v[96:99]
    ds_read_b64_tr_b16 v[68:69], v13 offset:36864
    ds_read_b64_tr_b16 v[70:71], v13 offset:37376
    v_mfma_f32_16x16x32_bf16 v[112:115], v[52:55], v[36:39], v[112:115]
    ds_read_b64_tr_b16 v[72:73], v14 offset:36864
    ds_read_b64_tr_b16 v[74:75], v14 offset:37376
    v_mfma_f32_16x16x32_bf16 v[100:103], v[56:59], v[32:35], v[100:103]
    ds_read_b64_tr_b16 v[76:77], v15 offset:36864
    v_mfma_f32_16x16x32_bf16 v[116:119], v[56:59], v[36:39], v[116:119]
    ds_read_b64_tr_b16 v[78:79], v15 offset:37376
    v_mfma_f32_16x16x32_bf16 v[104:107], v[60:63], v[32:35], v[104:107]
    v_mfma_f32_16x16x32_bf16 v[120:123], v[60:63], v[36:39], v[120:123]
    s_waitcnt vmcnt(4) lgkmcnt(0)
    s_barrier
    v_mfma_f32_16x16x32_bf16 v[92:95], v[64:67], v[40:43], v[92:95]
    ds_read_b128 v[32:35], v8 offset:0
    ds_read_b128 v[36:39], v8 offset:2048
    v_mfma_f32_16x16x32_bf16 v[108:111], v[64:67], v[44:47], v[108:111]
    ds_read_b64_tr_b16 v[48:49], v16 offset:0
    ds_read_b64_tr_b16 v[50:51], v16 offset:512
    v_mfma_f32_16x16x32_bf16 v[96:99], v[68:71], v[40:43], v[96:99]
    ds_read_b64_tr_b16 v[52:53], v17 offset:0
    ds_read_b64_tr_b16 v[54:55], v17 offset:512
    v_mfma_f32_16x16x32_bf16 v[112:115], v[68:71], v[44:47], v[112:115]
    ds_read_b64_tr_b16 v[56:57], v18 offset:0
    ds_read_b64_tr_b16 v[58:59], v18 offset:512
    v_mfma_f32_16x16x32_bf16 v[100:103], v[72:75], v[40:43], v[100:103]
    ds_read_b64_tr_b16 v[60:61], v19 offset:0
    v_mfma_f32_16x16x32_bf16 v[116:119], v[72:75], v[44:47], v[116:119]
    ds_read_b64_tr_b16 v[62:63], v19 offset:512
    v_mfma_f32_16x16x32_bf16 v[104:107], v[76:79], v[40:43], v[104:107]
    v_mfma_f32_16x16x32_bf16 v[120:123], v[76:79], v[44:47], v[120:123]
    s_waitcnt lgkmcnt(0)
    v_mfma_f32_16x16x32_bf16 v[92:95], v[48:51], v[32:35], v[92:95]
    ds_read_b128 v[40:43], v10 offset:0
    ds_read_b128 v[44:47], v10 offset:2048
    v_mfma_f32_16x16x32_bf16 v[108:111], v[48:51], v[36:39], v[108:111]
    ds_read_b64_tr_b16 v[64:65], v16 offset:4096
    ds_read_b64_tr_b16 v[66:67], v16 offset:4608
    v_mfma_f32_16x16x32_bf16 v[96:99], v[52:55], v[32:35], v[96:99]
    ds_read_b64_tr_b16 v[68:69], v17 offset:4096
    ds_read_b64_tr_b16 v[70:71], v17 offset:4608
    v_mfma_f32_16x16x32_bf16 v[112:115], v[52:55], v[36:39], v[112:115]
    ds_read_b64_tr_b16 v[72:73], v18 offset:4096
    ds_read_b64_tr_b16 v[74:75], v18 offset:4608
    v_mfma_f32_16x16x32_bf16 v[100:103], v[56:59], v[32:35], v[100:103]
    ds_read_b64_tr_b16 v[76:77], v19 offset:4096
    v_mfma_f32_16x16x32_bf16 v[116:119], v[56:59], v[36:39], v[116:119]
    ds_read_b64_tr_b16 v[78:79], v19 offset:4608
    v_mfma_f32_16x16x32_bf16 v[104:107], v[60:63], v[32:35], v[104:107]
    v_mfma_f32_16x16x32_bf16 v[120:123], v[60:63], v[36:39], v[120:123]
    s_waitcnt lgkmcnt(0)
    v_mfma_f32_16x16x32_bf16 v[92:95], v[64:67], v[40:43], v[92:95]
    v_mfma_f32_16x16x32_bf16 v[108:111], v[64:67], v[44:47], v[108:111]
    v_mfma_f32_16x16x32_bf16 v[96:99], v[68:71], v[40:43], v[96:99]
    v_mfma_f32_16x16x32_bf16 v[112:115], v[68:71], v[44:47], v[112:115]
    v_mfma_f32_16x16x32_bf16 v[100:103], v[72:75], v[40:43], v[100:103]
    v_mfma_f32_16x16x32_bf16 v[116:119], v[72:75], v[44:47], v[116:119]
    v_mfma_f32_16x16x32_bf16 v[104:107], v[76:79], v[40:43], v[104:107]
    v_mfma_f32_16x16x32_bf16 v[120:123], v[76:79], v[44:47], v[120:123]
    s_cmp_ge_u32 s33, 7
    s_cselect_b32 s43, 7, 0
    s_cselect_b32 s42, 1835008, 0
    s_sub_u32 s46, s33, s43
    s_lshl_b32 s46, s46, 11
    s_add_u32 s42, s42, s46
    s_mul_i32 s43, s39, 896
    s_add_u32 s42, s42, s43
    s_add_u32 s43, s42, 14336
    v_cvt_pk_bf16_f32 v32, v92, v93
    v_cvt_pk_bf16_f32 v33, v94, v95
    v_cvt_pk_bf16_f32 v34, v96, v97
    v_cvt_pk_bf16_f32 v35, v98, v99
    v_cvt_pk_bf16_f32 v36, v100, v101
    v_cvt_pk_bf16_f32 v37, v102, v103
    v_cvt_pk_bf16_f32 v38, v104, v105
    v_cvt_pk_bf16_f32 v39, v106, v107
    buffer_store_dwordx4 v[32:35], v240, s[28:31], s42 offen offset:0 sc1
    buffer_store_dwordx4 v[36:39], v240, s[28:31], s42 offen offset:1024 sc1
    v_cvt_pk_bf16_f32 v40, v108, v109
    v_cvt_pk_bf16_f32 v41, v110, v111
    v_cvt_pk_bf16_f32 v42, v112, v113
    v_cvt_pk_bf16_f32 v43, v114, v115
    v_cvt_pk_bf16_f32 v44, v116, v117
    v_cvt_pk_bf16_f32 v45, v118, v119
    v_cvt_pk_bf16_f32 v46, v120, v121
    v_cvt_pk_bf16_f32 v47, v122, v123
    buffer_store_dwordx4 v[40:43], v240, s[28:31], s43 offen offset:0 sc1
    buffer_store_dwordx4 v[44:47], v240, s[28:31], s43 offen offset:1024 sc1
    s_branch p1_done
p1_v:
    v_lshrrev_b32 v24, 2, v2
    v_lshl_add_u32 v25, v3, 3, v24
    v_lshlrev_b32 v25, 7, v25
    v_and_b32 v24, 2, v24
    v_and_b32 v26, 1, v3
    v_lshl_add_u32 v24, v26, 2, v24
    v_and_b32 v26, 3, v2
    v_lshlrev_b32 v24, 4, v24
    v_lshl_add_u32 v25, v26, 3, v25
    v_xor_b32 v28, 0, v24
    v_add_u32 v28, v28, v25
    v_xor_b32 v29, 32, v24
    v_add_u32 v29, v29, v25
    v_xor_b32 v30, 64, v24
    v_add_u32 v30, v30, v25
    v_xor_b32 v31, 96, v24
    v_add_u32 v31, v31, v25
    s_lshl_b32 s42, s41, 13
    s_add_u32 s42, s42, 16384
    s_add_u32 s43, s42, 65536
    v_add_u32 v16, s43, v28
    v_add_u32 v12, s42, v28
    v_add_u32 v17, s43, v29
    v_add_u32 v13, s42, v29
    v_add_u32 v18, s43, v30
    v_add_u32 v14, s42, v30
    v_add_u32 v19, s43, v31
    v_add_u32 v15, s42, v31
    s_sub_u32 s46, s33, 14
    s_lshl_b32 s47, s39, 6
    s_add_u32 s47, s47, 3670016
    s_lshl_b32 s44, s46, 6
    v_add_u32 v24, s44, v2
    v_add_u32 v24, 0, v24
    v_mul_u32_u24 v25, 2341, v24
    v_lshrrev_b32 v25, 16, v25
    v_mul_u32_u24 v26, 28, v25
    v_sub_u32 v26, v24, v26
    v_lshlrev_b32 v184, 17, v25
    v_lshrrev_b32 v27, 4, v26
    v_lshl_add_u32 v184, v27, 10, v184
    v_and_b32 v27, 15, v26
    v_lshl_add_u32 v184, v27, 4, v184
    v_lshl_add_u32 v184, v3, 8, v184
    v_add_u32 v24, s44, v2
    v_add_u32 v24, 16, v24
    v_mul_u32_u24 v25, 2341, v24
    v_lshrrev_b32 v25, 16, v25
    v_mul_u32_u24 v26, 28, v25
    v_sub_u32 v26, v24, v26
    v_lshlrev_b32 v185, 17, v25
    v_lshrrev_b32 v27, 4, v26
    v_lshl_add_u32 v185, v27, 10, v185
    v_and_b32 v27, 15, v26
    v_lshl_add_u32 v185, v27, 4, v185
    v_lshl_add_u32 v185, v3, 8, v185
    v_add_u32 v24, s44, v2
    v_add_u32 v24, 32, v24
    v_mul_u32_u24 v25, 2341, v24
    v_lshrrev_b32 v25, 16, v25
    v_mul_u32_u24 v26, 28, v25
    v_sub_u32 v26, v24, v26
    v_lshlrev_b32 v186, 17, v25
    v_lshrrev_b32 v27, 4, v26
    v_lshl_add_u32 v186, v27, 10, v186
    v_and_b32 v27, 15, v26
    v_lshl_add_u32 v186, v27, 4, v186
    v_lshl_add_u32 v186, v3, 8, v186
    v_add_u32 v24, s44, v2
    v_add_u32 v24, 48, v24
    v_mul_u32_u24 v25, 2341, v24
    v_lshrrev_b32 v25, 16, v25
    v_mul_u32_u24 v26, 28, v25
    v_sub_u32 v26, v24, v26
    v_lshlrev_b32 v187, 17, v25
    v_lshrrev_b32 v27, 4, v26
    v_lshl_add_u32 v187, v27, 10, v187
    v_and_b32 v27, 15, v26
    v_lshl_add_u32 v187, v27, 4, v187
    v_lshl_add_u32 v187, v3, 8, v187
    s_lshl_b32 s44, s46, 4
    s_mul_i32 s45, s44, 9363
    s_lshr_b32 s45, s45, 16
    v_add_u32 v24, s45, v3
    v_mul_u32_u24 v25, 7, v24
    v_add_u32 v25, 6, v25
    s_add_u32 s44, s44, 16
    v_lshlrev_b32 v24, 17, v24
    v_lshrrev_b32 v26, 2, v2
    v_lshl_add_u32 v24, v26, 4, v24
    v_and_b32 v27, 3, v2
    v_lshl_add_u32 v24, v27, 8, v24
    v_cmp_eq_u32 vcc, 0, v26
    v_mov_b32 v27, 0x3f803f80
    s_nop 0
    v_cndmask_b32 v188, 0, v27, vcc
    v_mov_b32 v189, v188
    v_mov_b32 v190, v188
    v_mov_b32 v191, v188
    v_cmp_gt_u32 vcc, s44, v25
    s_and_saveexec_b64 s[44:45], vcc
    buffer_store_dwordx4 v[188:191], v24, s[28:31], s47 offen offset:1216 sc1
    s_mov_b64 exec, -1
    s_waitcnt vmcnt(6)
    s_barrier
    ds_read_b128 v[32:35], v7 offset:0
    ds_read_b128 v[36:39], v7 offset:2048
    ds_read_b64_tr_b16 v[48:49], v12 offset:0
    ds_read_b64_tr_b16 v[50:51], v12 offset:512
    ds_read_b64_tr_b16 v[52:53], v13 offset:0
    ds_read_b64_tr_b16 v[54:55], v13 offset:512
    ds_read_b64_tr_b16 v[56:57], v14 offset:0
    ds_read_b64_tr_b16 v[58:59], v14 offset:512
    ds_read_b64_tr_b16 v[60:61], v15 offset:0
    ds_read_b64_tr_b16 v[62:63], v15 offset:512
    s_waitcnt lgkmcnt(0)
    v_mfma_f32_16x16x32_bf16 v[92:95], v[32:35], v[48:51], 0
    ds_read_b128 v[40:43], v9 offset:0
    ds_read_b128 v[44:47], v9 offset:2048
    ds_read_b64_tr_b16 v[64:65], v12 offset:4096
    v_mfma_f32_16x16x32_bf16 v[108:111], v[36:39], v[48:51], 0
    ds_read_b64_tr_b16 v[66:67], v12 offset:4608
    ds_read_b64_tr_b16 v[68:69], v13 offset:4096
    v_mfma_f32_16x16x32_bf16 v[96:99], v[32:35], v[52:55], 0
    ds_read_b64_tr_b16 v[70:71], v13 offset:4608
    ds_read_b64_tr_b16 v[72:73], v14 offset:4096
    v_mfma_f32_16x16x32_bf16 v[112:115], v[36:39], v[52:55], 0
    ds_read_b64_tr_b16 v[74:75], v14 offset:4608
    ds_read_b64_tr_b16 v[76:77], v15 offset:4096
    v_mfma_f32_16x16x32_bf16 v[100:103], v[32:35], v[56:59], 0
    ds_read_b64_tr_b16 v[78:79], v15 offset:4608
    s_add_u32 m0, s36, 65536
    s_nop 0
    buffer_load_dwordx4 v4, s[20:23], s35 offen lds
    buffer_load_dwordx4 v5, s[20:23], s35 offen offset:1024 lds
    s_add_u32 s35, s35, 128
    v_mfma_f32_16x16x32_bf16 v[116:119], v[36:39], v[56:59], 0
    s_add_u32 m0, s37, 65536
    s_nop 0
    buffer_load_dwordx4 v6, s[24:27], s34 offen lds
    s_add_u32 s34, s34, s38
    s_add_u32 m0, s37, 69632
    s_nop 0
    buffer_load_dwordx4 v6, s[24:27], s34 offen lds
    s_add_u32 s34, s34, s38
    v_mfma_f32_16x16x32_bf16 v[104:107], v[32:35], v[60:63], 0
    v_mfma_f32_16x16x32_bf16 v[120:123], v[36:39], v[60:63], 0
    s_waitcnt vmcnt(6) lgkmcnt(0)
    s_barrier
    v_mfma_f32_16x16x32_bf16 v[92:95], v[40:43], v[64:67], v[92:95]
    ds_read_b128 v[32:35], v7 offset:32768
    ds_read_b128 v[36:39], v7 offset:34816
    ds_read_b64_tr_b16 v[48:49], v12 offset:32768
    v_mfma_f32_16x16x32_bf16 v[108:111], v[44:47], v[64:67], v[108:111]
    ds_read_b64_tr_b16 v[50:51], v12 offset:33280
    ds_read_b64_tr_b16 v[52:53], v13 offset:32768
    v_mfma_f32_16x16x32_bf16 v[96:99], v[40:43], v[68:71], v[96:99]
    ds_read_b64_tr_b16 v[54:55], v13 offset:33280
    ds_read_b64_tr_b16 v[56:57], v14 offset:32768
    v_mfma_f32_16x16x32_bf16 v[112:115], v[44:47], v[68:71], v[112:115]
    ds_read_b64_tr_b16 v[58:59], v14 offset:33280
    ds_read_b64_tr_b16 v[60:61], v15 offset:32768
    v_mfma_f32_16x16x32_bf16 v[100:103], v[40:43], v[72:75], v[100:103]
    ds_read_b64_tr_b16 v[62:63], v15 offset:33280
    s_add_u32 m0, s36, 98304
    s_nop 0
    buffer_load_dwordx4 v4, s[20:23], s35 offen lds
    buffer_load_dwordx4 v5, s[20:23], s35 offen offset:1024 lds
    s_add_u32 s35, s35, 128
    v_mfma_f32_16x16x32_bf16 v[116:119], v[44:47], v[72:75], v[116:119]
    s_add_u32 m0, s37, 98304
    s_nop 0
    buffer_load_dwordx4 v6, s[24:27], s34 offen lds
    s_add_u32 s34, s34, s38
    s_add_u32 m0, s37, 102400
    s_nop 0
    buffer_load_dwordx4 v6, s[24:27], s34 offen lds
    s_add_u32 s34, s34, s38
    v_mfma_f32_16x16x32_bf16 v[104:107], v[40:43], v[76:79], v[104:107]
    v_mfma_f32_16x16x32_bf16 v[120:123], v[44:47], v[76:79], v[120:123]
    s_waitcnt lgkmcnt(0)
    v_mfma_f32_16x16x32_bf16 v[92:95], v[32:35], v[48:51], v[92:95]
    ds_read_b128 v[40:43], v9 offset:32768
    ds_read_b128 v[44:47], v9 offset:34816
    ds_read_b64_tr_b16 v[64:65], v12 offset:36864
    v_mfma_f32_16x16x32_bf16 v[108:111], v[36:39], v[48:51], v[108:111]
    ds_read_b64_tr_b16 v[66:67], v12 offset:37376
    ds_read_b64_tr_b16 v[68:69], v13 offset:36864
    v_mfma_f32_16x16x32_bf16 v[96:99], v[32:35], v[52:55], v[96:99]
    ds_read_b64_tr_b16 v[70:71], v13 offset:37376
    ds_read_b64_tr_b16 v[72:73], v14 offset:36864
    v_mfma_f32_16x16x32_bf16 v[112:115], v[36:39], v[52:55], v[112:115]
    ds_read_b64_tr_b16 v[74:75], v14 offset:37376
    ds_read_b64_tr_b16 v[76:77], v15 offset:36864
    v_mfma_f32_16x16x32_bf16 v[100:103], v[32:35], v[56:59], v[100:103]
    ds_read_b64_tr_b16 v[78:79], v15 offset:37376
    s_add_u32 m0, s36, 0
    s_nop 0
    buffer_load_dwordx4 v4, s[20:23], s35 offen lds
    buffer_load_dwordx4 v5, s[20:23], s35 offen offset:1024 lds
    s_add_u32 s35, s35, 128
    v_mfma_f32_16x16x32_bf16 v[116:119], v[36:39], v[56:59], v[116:119]
    s_add_u32 m0, s37, 0
    s_nop 0
    buffer_load_dwordx4 v6, s[24:27], s34 offen lds
    s_add_u32 s34, s34, s38
    s_add_u32 m0, s37, 4096
    s_nop 0
    buffer_load_dwordx4 v6, s[24:27], s34 offen lds
    s_add_u32 s34, s34, s38
    v_mfma_f32_16x16x32_bf16 v[104:107], v[32:35], v[60:63], v[104:107]
    v_mfma_f32_16x16x32_bf16 v[120:123], v[36:39], v[60:63], v[120:123]
    s_waitcnt vmcnt(8) lgkmcnt(0)
    s_barrier
    v_mfma_f32_16x16x32_bf16 v[92:95], v[40:43], v[64:67], v[92:95]
    ds_read_b128 v[32:35], v8 offset:0
    ds_read_b128 v[36:39], v8 offset:2048
    v_mfma_f32_16x16x32_bf16 v[108:111], v[44:47], v[64:67], v[108:111]
    ds_read_b64_tr_b16 v[48:49], v16 offset:0
    ds_read_b64_tr_b16 v[50:51], v16 offset:512
    v_mfma_f32_16x16x32_bf16 v[96:99], v[40:43], v[68:71], v[96:99]
    ds_read_b64_tr_b16 v[52:53], v17 offset:0
    ds_read_b64_tr_b16 v[54:55], v17 offset:512
    v_mfma_f32_16x16x32_bf16 v[112:115], v[44:47], v[68:71], v[112:115]
    ds_read_b64_tr_b16 v[56:57], v18 offset:0
    ds_read_b64_tr_b16 v[58:59], v18 offset:512
    v_mfma_f32_16x16x32_bf16 v[100:103], v[40:43], v[72:75], v[100:103]
    ds_read_b64_tr_b16 v[60:61], v19 offset:0
    v_mfma_f32_16x16x32_bf16 v[116:119], v[44:47], v[72:75], v[116:119]
    ds_read_b64_tr_b16 v[62:63], v19 offset:512
    v_mfma_f32_16x16x32_bf16 v[104:107], v[40:43], v[76:79], v[104:107]
    v_mfma_f32_16x16x32_bf16 v[120:123], v[44:47], v[76:79], v[120:123]
    s_waitcnt lgkmcnt(0)
    v_mfma_f32_16x16x32_bf16 v[92:95], v[32:35], v[48:51], v[92:95]
    ds_read_b128 v[40:43], v10 offset:0
    ds_read_b128 v[44:47], v10 offset:2048
    ds_read_b64_tr_b16 v[64:65], v16 offset:4096
    v_mfma_f32_16x16x32_bf16 v[108:111], v[36:39], v[48:51], v[108:111]
    ds_read_b64_tr_b16 v[66:67], v16 offset:4608
    ds_read_b64_tr_b16 v[68:69], v17 offset:4096
    v_mfma_f32_16x16x32_bf16 v[96:99], v[32:35], v[52:55], v[96:99]
    ds_read_b64_tr_b16 v[70:71], v17 offset:4608
    ds_read_b64_tr_b16 v[72:73], v18 offset:4096
    v_mfma_f32_16x16x32_bf16 v[112:115], v[36:39], v[52:55], v[112:115]
    ds_read_b64_tr_b16 v[74:75], v18 offset:4608
    ds_read_b64_tr_b16 v[76:77], v19 offset:4096
    v_mfma_f32_16x16x32_bf16 v[100:103], v[32:35], v[56:59], v[100:103]
    ds_read_b64_tr_b16 v[78:79], v19 offset:4608
    s_add_u32 m0, s36, 32768
    s_nop 0
    buffer_load_dwordx4 v4, s[20:23], s35 offen lds
    buffer_load_dwordx4 v5, s[20:23], s35 offen offset:1024 lds
    s_add_u32 s35, s35, 128
    v_mfma_f32_16x16x32_bf16 v[116:119], v[36:39], v[56:59], v[116:119]
    s_add_u32 m0, s37, 32768
    s_nop 0
    buffer_load_dwordx4 v6, s[24:27], s34 offen lds
    s_add_u32 s34, s34, s38
    s_add_u32 m0, s37, 36864
    s_nop 0
    buffer_load_dwordx4 v6, s[24:27], s34 offen lds
    s_add_u32 s34, s34, s38
    v_mfma_f32_16x16x32_bf16 v[104:107], v[32:35], v[60:63], v[104:107]
    v_mfma_f32_16x16x32_bf16 v[120:123], v[36:39], v[60:63], v[120:123]
    s_waitcnt vmcnt(8) lgkmcnt(0)
    s_barrier
    v_mfma_f32_16x16x32_bf16 v[92:95], v[40:43], v[64:67], v[92:95]
    ds_read_b128 v[32:35], v8 offset:32768
    ds_read_b128 v[36:39], v8 offset:34816
    v_mfma_f32_16x16x32_bf16 v[108:111], v[44:47], v[64:67], v[108:111]
    ds_read_b64_tr_b16 v[48:49], v16 offset:32768
    ds_read_b64_tr_b16 v[50:51], v16 offset:33280
    v_mfma_f32_16x16x32_bf16 v[96:99], v[40:43], v[68:71], v[96:99]
    ds_read_b64_tr_b16 v[52:53], v17 offset:32768
    ds_read_b64_tr_b16 v[54:55], v17 offset:33280
    v_mfma_f32_16x16x32_bf16 v[112:115], v[44:47], v[68:71], v[112:115]
    ds_read_b64_tr_b16 v[56:57], v18 offset:32768
    ds_read_b64_tr_b16 v[58:59], v18 offset:33280
    v_mfma_f32_16x16x32_bf16 v[100:103], v[40:43], v[72:75], v[100:103]
    ds_read_b64_tr_b16 v[60:61], v19 offset:32768
    v_mfma_f32_16x16x32_bf16 v[116:119], v[44:47], v[72:75], v[116:119]
    ds_read_b64_tr_b16 v[62:63], v19 offset:33280
    v_mfma_f32_16x16x32_bf16 v[104:107], v[40:43], v[76:79], v[104:107]
    v_mfma_f32_16x16x32_bf16 v[120:123], v[44:47], v[76:79], v[120:123]
    s_waitcnt lgkmcnt(0)
    v_mfma_f32_16x16x32_bf16 v[92:95], v[32:35], v[48:51], v[92:95]
    ds_read_b128 v[40:43], v10 offset:32768
    ds_read_b128 v[44:47], v10 offset:34816
    ds_read_b64_tr_b16 v[64:65], v16 offset:36864
    v_mfma_f32_16x16x32_bf16 v[108:111], v[36:39], v[48:51], v[108:111]
    ds_read_b64_tr_b16 v[66:67], v16 offset:37376
    ds_read_b64_tr_b16 v[68:69], v17 offset:36864
    v_mfma_f32_16x16x32_bf16 v[96:99], v[32:35], v[52:55], v[96:99]
    ds_read_b64_tr_b16 v[70:71], v17 offset:37376
    ds_read_b64_tr_b16 v[72:73], v18 offset:36864
    v_mfma_f32_16x16x32_bf16 v[112:115], v[36:39], v[52:55], v[112:115]
    ds_read_b64_tr_b16 v[74:75], v18 offset:37376
    ds_read_b64_tr_b16 v[76:77], v19 offset:36864
    v_mfma_f32_16x16x32_bf16 v[100:103], v[32:35], v[56:59], v[100:103]
    ds_read_b64_tr_b16 v[78:79], v19 offset:37376
    s_add_u32 m0, s36, 65536
    s_nop 0
    buffer_load_dwordx4 v4, s[20:23], s35 offen lds
    buffer_load_dwordx4 v5, s[20:23], s35 offen offset:1024 lds
    s_add_u32 s35, s35, 128
    v_mfma_f32_16x16x32_bf16 v[116:119], v[36:39], v[56:59], v[116:119]
    s_add_u32 m0, s37, 65536
    s_nop 0
    buffer_load_dwordx4 v6, s[24:27], s34 offen lds
    s_add_u32 s34, s34, s38
    s_add_u32 m0, s37, 69632
    s_nop 0
    buffer_load_dwordx4 v6, s[24:27], s34 offen lds
    s_add_u32 s34, s34, s38
    v_mfma_f32_16x16x32_bf16 v[104:107], v[32:35], v[60:63], v[104:107]
    v_mfma_f32_16x16x32_bf16 v[120:123], v[36:39], v[60:63], v[120:123]
    s_waitcnt vmcnt(8) lgkmcnt(0)
    s_barrier
    v_mfma_f32_16x16x32_bf16 v[92:95], v[40:43], v[64:67], v[92:95]
    ds_read_b128 v[32:35], v7 offset:0
    ds_read_b128 v[36:39], v7 offset:2048
    v_mfma_f32_16x16x32_bf16 v[108:111], v[44:47], v[64:67], v[108:111]
    ds_read_b64_tr_b16 v[48:49], v12 offset:0
    ds_read_b64_tr_b16 v[50:51], v12 offset:512
    v_mfma_f32_16x16x32_bf16 v[96:99], v[40:43], v[68:71], v[96:99]
    ds_read_b64_tr_b16 v[52:53], v13 offset:0
    ds_read_b64_tr_b16 v[54:55], v13 offset:512
    v_mfma_f32_16x16x32_bf16 v[112:115], v[44:47], v[68:71], v[112:115]
    ds_read_b64_tr_b16 v[56:57], v14 offset:0
    ds_read_b64_tr_b16 v[58:59], v14 offset:512
    v_mfma_f32_16x16x32_bf16 v[100:103], v[40:43], v[72:75], v[100:103]
    ds_read_b64_tr_b16 v[60:61], v15 offset:0
    ds_read_b64_tr_b16 v[62:63], v15 offset:512
    v_mfma_f32_16x16x32_bf16 v[116:119], v[44:47], v[72:75], v[116:119]
    s_waitcnt vmcnt(21)
    v_readfirstlane_b32 s84, v200
    s_sub_i32 s85, s82, s84
    s_cmp_lt_i32 s85, 1500
    s_cselect_b32 s85, s84, 0
    s_cmp_lg_u32 s85, 0
    s_cbranch_scc1 tk_5
    v_mov_b32 v252, 0
    s_mov_b32 s93, 0
tok_6:
    global_load_dword v253, v252, s[56:57] sc1
    s_add_u32 s93, s93, 1
    s_waitcnt vmcnt(0)
    v_readfirstlane_b32 s84, v253
    s_cmp_ge_u32 s93, 0x4000
    s_cbranch_scc1 tok_7
    s_sub_i32 s85, s82, s84
    s_cmp_lt_i32 s85, 1500
    s_cselect_b32 s85, s84, 0
    s_cmp_lg_u32 s85, 0
    s_cbranch_scc0 tok_6
tok_7:
tk_5:
    v_mfma_f32_16x16x32_bf16 v[104:107], v[40:43], v[76:79], v[104:107]
    v_mfma_f32_16x16x32_bf16 v[120:123], v[44:47], v[76:79], v[120:123]
    s_waitcnt lgkmcnt(0)
    v_mfma_f32_16x16x32_bf16 v[92:95], v[32:35], v[48:51], v[92:95]
    ds_read_b128 v[40:43], v9 offset:0
    ds_read_b128 v[44:47], v9 offset:2048
    v_mfma_f32_16x16x32_bf16 v[108:111], v[36:39], v[48:51], v[108:111]
    ds_read_b64_tr_b16 v[64:65], v12 offset:4096
    ds_read_b64_tr_b16 v[66:67], v12 offset:4608
    v_mfma_f32_16x16x32_bf16 v[96:99], v[32:35], v[52:55], v[96:99]
    ds_read_b64_tr_b16 v[68:69], v13 offset:4096
    ds_read_b64_tr_b16 v[70:71], v13 offset:4608
    v_mfma_f32_16x16x32_bf16 v[112:115], v[36:39], v[52:55], v[112:115]
    ds_read_b64_tr_b16 v[72:73], v14 offset:4096
    ds_read_b64_tr_b16 v[74:75], v14 offset:4608
    v_mfma_f32_16x16x32_bf16 v[100:103], v[32:35], v[56:59], v[100:103]
    ds_read_b64_tr_b16 v[76:77], v15 offset:4096
    ds_read_b64_tr_b16 v[78:79], v15 offset:4608
    v_mfma_f32_16x16x32_bf16 v[116:119], v[36:39], v[56:59], v[116:119]
    s_lshl_b32 s60, s2, 3
    s_add_u32 s60, s60, s19
    s_lshl_b32 s60, s60, 10
    s_mov_b32 s72, s64
    s_and_b32 s73, s65, 0xffff
    s_mov_b32 s74, 401408
    s_mov_b32 s75, 0x00020000
    s_sub_u32 s61, s60, 0
    buffer_load_dwordx4 v[204:207], v240, s[72:75], s61 offen
    s_mov_b32 s72, s66
    s_and_b32 s73, s67, 0xffff
    s_mov_b32 s74, 1605632
    s_mov_b32 s75, 0x00020000
    s_sub_u32 s61, s60, 0
    buffer_load_dwordx4 v[204:207], v240, s[72:75], s61 offen
    s_mov_b32 s72, s62
    s_and_b32 s73, s63, 0xffff
    s_mov_b32 s74, 401408
    s_mov_b32 s75, 0x00020000
    s_sub_u32 s61, s60, 401408
    buffer_load_dwordx4 v[204:207], v240, s[72:75], s61 offen
    s_mov_b32 s72, s68
    s_and_b32 s73, s69, 0xffff
    s_mov_b32 s74, 1605632
    s_mov_b32 s75, 0x00020000
    s_sub_u32 s61, s60, 229376
    buffer_load_dwordx4 v[204:207], v240, s[72:75], s61 offen
    v_mfma_f32_16x16x32_bf16 v[104:107], v[32:35], v[60:63], v[104:107]
    v_mfma_f32_16x16x32_bf16 v[120:123], v[36:39], v[60:63], v[120:123]
    s_waitcnt vmcnt(8) lgkmcnt(0)
    s_barrier
    v_mfma_f32_16x16x32_bf16 v[92:95], v[40:43], v[64:67], v[92:95]
    ds_read_b128 v[32:35], v7 offset:32768
    ds_read_b128 v[36:39], v7 offset:34816
    v_mfma_f32_16x16x32_bf16 v[108:111], v[44:47], v[64:67], v[108:111]
    ds_read_b64_tr_b16 v[48:49], v12 offset:32768
    ds_read_b64_tr_b16 v[50:51], v12 offset:33280
    v_mfma_f32_16x16x32_bf16 v[96:99], v[40:43], v[68:71], v[96:99]
    ds_read_b64_tr_b16 v[52:53], v13 offset:32768
    ds_read_b64_tr_b16 v[54:55], v13 offset:33280
    v_mfma_f32_16x16x32_bf16 v[112:115], v[44:47], v[68:71], v[112:115]
    ds_read_b64_tr_b16 v[56:57], v14 offset:32768
    ds_read_b64_tr_b16 v[58:59], v14 offset:33280
    v_mfma_f32_16x16x32_bf16 v[100:103], v[40:43], v[72:75], v[100:103]
    ds_read_b64_tr_b16 v[60:61], v15 offset:32768
    v_mfma_f32_16x16x32_bf16 v[116:119], v[44:47], v[72:75], v[116:119]
    ds_read_b64_tr_b16 v[62:63], v15 offset:33280
    v_mfma_f32_16x16x32_bf16 v[104:107], v[40:43], v[76:79], v[104:107]
    v_mfma_f32_16x16x32_bf16 v[120:123], v[44:47], v[76:79], v[120:123]
    s_waitcnt lgkmcnt(0)
    v_mfma_f32_16x16x32_bf16 v[92:95], v[32:35], v[48:51], v[92:95]
    ds_read_b128 v[40:43], v9 offset:32768
    ds_read_b128 v[44:47], v9 offset:34816
    v_mfma_f32_16x16x32_bf16 v[108:111], v[36:39], v[48:51], v[108:111]
    ds_read_b64_tr_b16 v[64:65], v12 offset:36864
    ds_read_b64_tr_b16 v[66:67], v12 offset:37376
    v_mfma_f32_16x16x32_bf16 v[96:99], v[32:35], v[52:55], v[96:99]
    ds_read_b64_tr_b16 v[68:69], v13 offset:36864
    ds_read_b64_tr_b16 v[70:71], v13 offset:37376
    v_mfma_f32_16x16x32_bf16 v[112:115], v[36:39], v[52:55], v[112:115]
    ds_read_b64_tr_b16 v[72:73], v14 offset:36864
    ds_read_b64_tr_b16 v[74:75], v14 offset:37376
    v_mfma_f32_16x16x32_bf16 v[100:103], v[32:35], v[56:59], v[100:103]
    ds_read_b64_tr_b16 v[76:77], v15 offset:36864
    v_mfma_f32_16x16x32_bf16 v[116:119], v[36:39], v[56:59], v[116:119]
    ds_read_b64_tr_b16 v[78:79], v15 offset:37376
    v_mfma_f32_16x16x32_bf16 v[104:107], v[32:35], v[60:63], v[104:107]
    v_mfma_f32_16x16x32_bf16 v[120:123], v[36:39], v[60:63], v[120:123]
    s_waitcnt vmcnt(4) lgkmcnt(0)
    s_barrier
    v_mfma_f32_16x16x32_bf16 v[92:95], v[40:43], v[64:67], v[92:95]
    ds_read_b128 v[32:35], v8 offset:0
    ds_read_b128 v[36:39], v8 offset:2048
    v_mfma_f32_16x16x32_bf16 v[108:111], v[44:47], v[64:67], v[108:111]
    ds_read_b64_tr_b16 v[48:49], v16 offset:0
    ds_read_b64_tr_b16 v[50:51], v16 offset:512
    v_mfma_f32_16x16x32_bf16 v[96:99], v[40:43], v[68:71], v[96:99]
    ds_read_b64_tr_b16 v[52:53], v17 offset:0
    ds_read_b64_tr_b16 v[54:55], v17 offset:512
    v_mfma_f32_16x16x32_bf16 v[112:115], v[44:47], v[68:71], v[112:115]
    ds_read_b64_tr_b16 v[56:57], v18 offset:0
    ds_read_b64_tr_b16 v[58:59], v18 offset:512
    v_mfma_f32_16x16x32_bf16 v[100:103], v[40:43], v[72:75], v[100:103]
    ds_read_b64_tr_b16 v[60:61], v19 offset:0
    v_mfma_f32_16x16x32_bf16 v[116:119], v[44:47], v[72:75], v[116:119]
    ds_read_b64_tr_b16 v[62:63], v19 offset:512
    v_mfma_f32_16x16x32_bf16 v[104:107], v[40:43], v[76:79], v[104:107]
    v_mfma_f32_16x16x32_bf16 v[120:123], v[44:47], v[76:79], v[120:123]
    s_waitcnt lgkmcnt(0)
    v_mfma_f32_16x16x32_bf16 v[92:95], v[32:35], v[48:51], v[92:95]
    ds_read_b128 v[40:43], v10 offset:0
    ds_read_b128 v[44:47], v10 offset:2048
    v_mfma_f32_16x16x32_bf16 v[108:111], v[36:39], v[48:51], v[108:111]
    ds_read_b64_tr_b16 v[64:65], v16 offset:4096
    ds_read_b64_tr_b16 v[66:67], v16 offset:4608
    v_mfma_f32_16x16x32_bf16 v[96:99], v[32:35], v[52:55], v[96:99]
    ds_read_b64_tr_b16 v[68:69], v17 offset:4096
    ds_read_b64_tr_b16 v[70:71], v17 offset:4608
    v_mfma_f32_16x16x32_bf16 v[112:115], v[36:39], v[52:55], v[112:115]
    ds_read_b64_tr_b16 v[72:73], v18 offset:4096
    ds_read_b64_tr_b16 v[74:75], v18 offset:4608
    v_mfma_f32_16x16x32_bf16 v[100:103], v[32:35], v[56:59], v[100:103]
    ds_read_b64_tr_b16 v[76:77], v19 offset:4096
    v_mfma_f32_16x16x32_bf16 v[116:119], v[36:39], v[56:59], v[116:119]
    ds_read_b64_tr_b16 v[78:79], v19 offset:4608
    v_mfma_f32_16x16x32_bf16 v[104:107], v[32:35], v[60:63], v[104:107]
    v_mfma_f32_16x16x32_bf16 v[120:123], v[36:39], v[60:63], v[120:123]
    s_waitcnt lgkmcnt(0)
    v_mfma_f32_16x16x32_bf16 v[92:95], v[40:43], v[64:67], v[92:95]
    v_mfma_f32_16x16x32_bf16 v[108:111], v[44:47], v[64:67], v[108:111]
    v_mfma_f32_16x16x32_bf16 v[96:99], v[40:43], v[68:71], v[96:99]
    v_mfma_f32_16x16x32_bf16 v[112:115], v[44:47], v[68:71], v[112:115]
    v_mfma_f32_16x16x32_bf16 v[100:103], v[40:43], v[72:75], v[100:103]
    v_mfma_f32_16x16x32_bf16 v[116:119], v[44:47], v[72:75], v[116:119]
    v_mfma_f32_16x16x32_bf16 v[104:107], v[40:43], v[76:79], v[104:107]
    v_mfma_f32_16x16x32_bf16 v[120:123], v[44:47], v[76:79], v[120:123]
    s_nop 4
    v_cvt_pk_bf16_f32 v32, v92, v93
    v_cvt_pk_bf16_f32 v33, v94, v95
    v_cvt_pk_bf16_f32 v34, v108, v109
    v_cvt_pk_bf16_f32 v35, v110, v111
    buffer_store_dwordx4 v[32:35], v184, s[28:31], s47 offen sc1
    v_cvt_pk_bf16_f32 v36, v96, v97
    v_cvt_pk_bf16_f32 v37, v98, v99
    v_cvt_pk_bf16_f32 v38, v112, v113
    v_cvt_pk_bf16_f32 v39, v114, v115
    buffer_store_dwordx4 v[36:39], v185, s[28:31], s47 offen sc1
    v_cvt_pk_bf16_f32 v40, v100, v101
    v_cvt_pk_bf16_f32 v41, v102, v103
    v_cvt_pk_bf16_f32 v42, v116, v117
    v_cvt_pk_bf16_f32 v43, v118, v119
    buffer_store_dwordx4 v[40:43], v186, s[28:31], s47 offen sc1
    v_cvt_pk_bf16_f32 v44, v104, v105
    v_cvt_pk_bf16_f32 v45, v106, v107
    v_cvt_pk_bf16_f32 v46, v120, v121
    v_cvt_pk_bf16_f32 v47, v122, v123
    buffer_store_dwordx4 v[44:47], v187, s[28:31], s47 offen sc1
    s_branch p1_done
p1_w1:
    s_lshl_b32 s42, s17, 1
    v_add_u32 v201, s42, v1
    v_writelane_b32 v201, s46, 2
    v_lshlrev_b32 v201, 7, v201
    v_add_u32 v201, 28672, v201
    v_add_u32 v202, s39, v2
    v_lshlrev_b32 v202, 3, v202
    s_mov_b32 s44, 11681792
    s_lshl_b32 s45, s46, 8
    s_add_u32 s45, s45, 11698176
    v_xor_b32 v203, 16, v243
    s_add_u32 s52, s58, 5767168
    s_addc_u32 s53, s59, 0
    s_and_b32 s53, s53, 0xffff
    s_mov_b32 s54, 1835008
    s_mov_b32 s55, 0x00020000
    s_lshl_b32 s47, s46, 3
    v_add_u32 v24, s47, v3
    v_mul_u32_u24 v25, 4682, v24
    v_lshrrev_b32 v25, 16, v25
    v_lshrrev_b32 v26, 1, v25
    v_add_u32 v26, 1, v26
    v_and_b32 v25, 1, v25
    v_sub_u32 v27, 0, v25
    v_xor_b32 v26, v26, v27
    v_add_u32 v26, v26, v25
    v_add_u32 v26, v26, v2
    v_add_u32 v26, s39, v26
    v_lshrrev_b32 v25, 4, v26
    v_mul_u32_u24 v25, 14336, v25
    v_and_b32 v27, 15, v26
    v_lshl_add_u32 v25, v27, 4, v25
    v_lshl_add_u32 v25, v24, 8, v25
    v_cmp_gt_u32 vcc, 2048, v26
    v_mov_b32 v27, 0x80000000
    s_nop 0
    v_cndmask_b32 v184, v27, v25, vcc
    v_add_u32 v26, 16, v26
    v_lshrrev_b32 v25, 4, v26
    v_mul_u32_u24 v25, 14336, v25
    v_and_b32 v27, 15, v26
    v_lshl_add_u32 v25, v27, 4, v25
    v_lshl_add_u32 v25, v24, 8, v25
    v_cmp_gt_u32 vcc, 2048, v26
    v_mov_b32 v27, 0x80000000
    s_nop 0
    v_cndmask_b32 v186, v27, v25, vcc
    v_add_u32 v24, s47, v3
    v_add_u32 v24, 4, v24
    v_mul_u32_u24 v25, 4682, v24
    v_lshrrev_b32 v25, 16, v25
    v_lshrrev_b32 v26, 1, v25
    v_add_u32 v26, 1, v26
    v_and_b32 v25, 1, v25
    v_sub_u32 v27, 0, v25
    v_xor_b32 v26, v26, v27
    v_add_u32 v26, v26, v25
    v_add_u32 v26, v26, v2
    v_add_u32 v26, s39, v26
    v_lshrrev_b32 v25, 4, v26
    v_mul_u32_u24 v25, 14336, v25
    v_and_b32 v27, 15, v26
    v_lshl_add_u32 v25, v27, 4, v25
    v_lshl_add_u32 v25, v24, 8, v25
    v_cmp_gt_u32 vcc, 2048, v26
    v_mov_b32 v27, 0x80000000
    s_nop 0
    v_cndmask_b32 v185, v27, v25, vcc
    v_add_u32 v26, 16, v26
    v_lshrrev_b32 v25, 4, v26
    v_mul_u32_u24 v25, 14336, v25
    v_and_b32 v27, 15, v26
    v_lshl_add_u32 v25, v27, 4, v25
    v_lshl_add_u32 v25, v24, 8, v25
    v_cmp_gt_u32 vcc, 2048, v26
    v_mov_b32 v27, 0x80000000
    s_nop 0
    v_cndmask_b32 v187, v27, v25, vcc
    s_cmp_lg_u32 s40, 0
    s_cbranch_scc1 p1_zd
    s_cmp_eq_u32 s17, 0
    s_cselect_b32 s48, 0, 1
    s_cbranch_scc1 p1_z
    s_cmp_lg_u32 s17, 15
    s_cbranch_scc1 p1_zd
p1_z:
    v_and_b32 v24, 7, v1
    v_add_u32 v24, s47, v24
    v_mul_u32_u24 v25, 4682, v24
    v_lshrrev_b32 v25, 16, v25
    v_lshrrev_b32 v26, 3, v1
    v_lshrrev_b32 v27, 1, v25
    v_cmp_le_u32 s[50:51], v26, v27
    v_and_b32 v25, 1, v25
    v_cmp_eq_u32 vcc, s48, v25
    s_and_b64 s[50:51], s[50:51], vcc
    v_sub_u32 v27, 15, v26
    s_cmp_eq_u32 s48, 0
    s_cselect_b32 s49, 0, 1820672
    s_cbranch_scc1 p1_z2
    v_mov_b32 v26, v27
p1_z2:
    v_lshlrev_b32 v26, 4, v26
    v_lshl_add_u32 v26, v24, 8, v26
    v_mov_b32 v188, 0
    v_mov_b32 v189, 0
    v_mov_b32 v190, 0
    v_mov_b32 v191, 0
    s_mov_b64 exec, s[50:51]
    buffer_store_dwordx4 v[188:191], v26, s[52:55], s49 offen sc1
    s_mov_b64 exec, -1
p1_zd:
    s_waitcnt vmcnt(5)
    s_barrier
    ds_read_b128 v[32:35], v7 offset:0
    ds_read_b128 v[36:39], v7 offset:2048
    ds_read_b64_tr_b16 v[48:49], v12 offset:0
    ds_read_b64_tr_b16 v[50:51], v12 offset:512
    ds_read_b64_tr_b16 v[52:53], v13 offset:0
    ds_read_b64_tr_b16 v[54:55], v13 offset:512
    ds_read_b64_tr_b16 v[56:57], v14 offset:0
    ds_read_b64_tr_b16 v[58:59], v14 offset:512
    ds_read_b64_tr_b16 v[60:61], v15 offset:0
    ds_read_b64_tr_b16 v[62:63], v15 offset:512
    s_waitcnt lgkmcnt(0)
    v_mfma_f32_16x16x32_bf16 v[92:95], v[48:51], v[32:35], 0
    ds_read_b128 v[40:43], v9 offset:0
    ds_read_b128 v[44:47], v9 offset:2048
    ds_read_b64_tr_b16 v[64:65], v12 offset:4096
    v_mfma_f32_16x16x32_bf16 v[108:111], v[48:51], v[36:39], 0
    ds_read_b64_tr_b16 v[66:67], v12 offset:4608
    ds_read_b64_tr_b16 v[68:69], v13 offset:4096
    v_mfma_f32_16x16x32_bf16 v[96:99], v[52:55], v[32:35], 0
    ds_read_b64_tr_b16 v[70:71], v13 offset:4608
    ds_read_b64_tr_b16 v[72:73], v14 offset:4096
    v_mfma_f32_16x16x32_bf16 v[112:115], v[52:55], v[36:39], 0
    ds_read_b64_tr_b16 v[74:75], v14 offset:4608
    ds_read_b64_tr_b16 v[76:77], v15 offset:4096
    v_mfma_f32_16x16x32_bf16 v[100:103], v[56:59], v[32:35], 0
    ds_read_b64_tr_b16 v[78:79], v15 offset:4608
    s_add_u32 m0, s36, 65536
    s_nop 0
    buffer_load_dwordx4 v4, s[20:23], s35 offen lds
    buffer_load_dwordx4 v5, s[20:23], s35 offen offset:1024 lds
    s_add_u32 s35, s35, 128
    v_mfma_f32_16x16x32_bf16 v[116:119], v[56:59], v[36:39], 0
    s_add_u32 m0, s37, 65536
    s_nop 0
    buffer_load_dwordx4 v6, s[24:27], s34 offen lds
    s_add_u32 s34, s34, s38
    s_add_u32 m0, s37, 69632
    s_nop 0
    buffer_load_dwordx4 v6, s[24:27], s34 offen lds
    s_add_u32 s34, s34, s38
    v_mfma_f32_16x16x32_bf16 v[104:107], v[60:63], v[32:35], 0
    v_mfma_f32_16x16x32_bf16 v[120:123], v[60:63], v[36:39], 0
    s_waitcnt vmcnt(5) lgkmcnt(0)
    s_barrier
    v_mfma_f32_16x16x32_bf16 v[92:95], v[64:67], v[40:43], v[92:95]
    ds_read_b128 v[32:35], v7 offset:32768
    ds_read_b128 v[36:39], v7 offset:34816
    ds_read_b64_tr_b16 v[48:49], v12 offset:32768
    v_mfma_f32_16x16x32_bf16 v[108:111], v[64:67], v[44:47], v[108:111]
    ds_read_b64_tr_b16 v[50:51], v12 offset:33280
    ds_read_b64_tr_b16 v[52:53], v13 offset:32768
    v_mfma_f32_16x16x32_bf16 v[96:99], v[68:71], v[40:43], v[96:99]
    ds_read_b64_tr_b16 v[54:55], v13 offset:33280
    ds_read_b64_tr_b16 v[56:57], v14 offset:32768
    v_mfma_f32_16x16x32_bf16 v[112:115], v[68:71], v[44:47], v[112:115]
    ds_read_b64_tr_b16 v[58:59], v14 offset:33280
    ds_read_b64_tr_b16 v[60:61], v15 offset:32768
    v_mfma_f32_16x16x32_bf16 v[100:103], v[72:75], v[40:43], v[100:103]
    ds_read_b64_tr_b16 v[62:63], v15 offset:33280
    s_add_u32 m0, s36, 98304
    s_nop 0
    buffer_load_dwordx4 v4, s[20:23], s35 offen lds
    buffer_load_dwordx4 v5, s[20:23], s35 offen offset:1024 lds
    s_add_u32 s35, s35, 128
    v_mfma_f32_16x16x32_bf16 v[116:119], v[72:75], v[44:47], v[116:119]
    s_add_u32 m0, s37, 98304
    s_nop 0
    buffer_load_dwordx4 v6, s[24:27], s34 offen lds
    s_add_u32 s34, s34, s38
    s_add_u32 m0, s37, 102400
    s_nop 0
    buffer_load_dwordx4 v6, s[24:27], s34 offen lds
    s_add_u32 s34, s34, s38
    v_mfma_f32_16x16x32_bf16 v[104:107], v[76:79], v[40:43], v[104:107]
    v_mfma_f32_16x16x32_bf16 v[120:123], v[76:79], v[44:47], v[120:123]
    s_waitcnt lgkmcnt(0)
    v_mfma_f32_16x16x32_bf16 v[92:95], v[48:51], v[32:35], v[92:95]
    ds_read_b128 v[40:43], v9 offset:32768
    ds_read_b128 v[44:47], v9 offset:34816
    ds_read_b64_tr_b16 v[64:65], v12 offset:36864
    v_mfma_f32_16x16x32_bf16 v[108:111], v[48:51], v[36:39], v[108:111]
    ds_read_b64_tr_b16 v[66:67], v12 offset:37376
    ds_read_b64_tr_b16 v[68:69], v13 offset:36864
    v_mfma_f32_16x16x32_bf16 v[96:99], v[52:55], v[32:35], v[96:99]
    ds_read_b64_tr_b16 v[70:71], v13 offset:37376
    ds_read_b64_tr_b16 v[72:73], v14 offset:36864
    v_mfma_f32_16x16x32_bf16 v[112:115], v[52:55], v[36:39], v[112:115]
    ds_read_b64_tr_b16 v[74:75], v14 offset:37376
    ds_read_b64_tr_b16 v[76:77], v15 offset:36864
    v_mfma_f32_16x16x32_bf16 v[100:103], v[56:59], v[32:35], v[100:103]
    ds_read_b64_tr_b16 v[78:79], v15 offset:37376
    s_add_u32 m0, s36, 0
    s_nop 0
    buffer_load_dwordx4 v4, s[20:23], s35 offen lds
    buffer_load_dwordx4 v5, s[20:23], s35 offen offset:1024 lds
    s_add_u32 s35, s35, 128
    v_mfma_f32_16x16x32_bf16 v[116:119], v[56:59], v[36:39], v[116:119]
    s_add_u32 m0, s37, 0
    s_nop 0
    buffer_load_dwordx4 v6, s[24:27], s34 offen lds
    s_add_u32 s34, s34, s38
    s_add_u32 m0, s37, 4096
    s_nop 0
    buffer_load_dwordx4 v6, s[24:27], s34 offen lds
    s_add_u32 s34, s34, s38
    v_mfma_f32_16x16x32_bf16 v[104:107], v[60:63], v[32:35], v[104:107]
    v_mfma_f32_16x16x32_bf16 v[120:123], v[60:63], v[36:39], v[120:123]
    s_waitcnt vmcnt(8) lgkmcnt(0)
    s_barrier
    v_mfma_f32_16x16x32_bf16 v[92:95], v[64:67], v[40:43], v[92:95]
    ds_read_b128 v[32:35], v8 offset:0
    ds_read_b128 v[36:39], v8 offset:2048
    v_mfma_f32_16x16x32_bf16 v[108:111], v[64:67], v[44:47], v[108:111]
    ds_read_b64_tr_b16 v[48:49], v16 offset:0
    ds_read_b64_tr_b16 v[50:51], v16 offset:512
    v_mfma_f32_16x16x32_bf16 v[96:99], v[68:71], v[40:43], v[96:99]
    ds_read_b64_tr_b16 v[52:53], v17 offset:0
    ds_read_b64_tr_b16 v[54:55], v17 offset:512
    v_mfma_f32_16x16x32_bf16 v[112:115], v[68:71], v[44:47], v[112:115]
    ds_read_b64_tr_b16 v[56:57], v18 offset:0
    ds_read_b64_tr_b16 v[58:59], v18 offset:512
    v_mfma_f32_16x16x32_bf16 v[100:103], v[72:75], v[40:43], v[100:103]
    ds_read_b64_tr_b16 v[60:61], v19 offset:0
    v_mfma_f32_16x16x32_bf16 v[116:119], v[72:75], v[44:47], v[116:119]
    ds_read_b64_tr_b16 v[62:63], v19 offset:512
    v_mfma_f32_16x16x32_bf16 v[104:107], v[76:79], v[40:43], v[104:107]
    v_mfma_f32_16x16x32_bf16 v[120:123], v[76:79], v[44:47], v[120:123]
    s_waitcnt lgkmcnt(0)
    v_mfma_f32_16x16x32_bf16 v[92:95], v[48:51], v[32:35], v[92:95]
    ds_read_b128 v[40:43], v10 offset:0
    ds_read_b128 v[44:47], v10 offset:2048
    ds_read_b64_tr_b16 v[64:65], v16 offset:4096
    v_mfma_f32_16x16x32_bf16 v[108:111], v[48:51], v[36:39], v[108:111]
    ds_read_b64_tr_b16 v[66:67], v16 offset:4608
    ds_read_b64_tr_b16 v[68:69], v17 offset:4096
    v_mfma_f32_16x16x32_bf16 v[96:99], v[52:55], v[32:35], v[96:99]
    ds_read_b64_tr_b16 v[70:71], v17 offset:4608
    ds_read_b64_tr_b16 v[72:73], v18 offset:4096
    v_mfma_f32_16x16x32_bf16 v[112:115], v[52:55], v[36:39], v[112:115]
    ds_read_b64_tr_b16 v[74:75], v18 offset:4608
    ds_read_b64_tr_b16 v[76:77], v19 offset:4096
    v_mfma_f32_16x16x32_bf16 v[100:103], v[56:59], v[32:35], v[100:103]
    ds_read_b64_tr_b16 v[78:79], v19 offset:4608
    s_add_u32 m0, s36, 32768
    s_nop 0
    buffer_load_dwordx4 v4, s[20:23], s35 offen lds
    buffer_load_dwordx4 v5, s[20:23], s35 offen offset:1024 lds
    s_add_u32 s35, s35, 128
    v_mfma_f32_16x16x32_bf16 v[116:119], v[56:59], v[36:39], v[116:119]
    s_add_u32 m0, s37, 32768
    s_nop 0
    buffer_load_dwordx4 v6, s[24:27], s34 offen lds
    s_add_u32 s34, s34, s38
    s_add_u32 m0, s37, 36864
    s_nop 0
    buffer_load_dwordx4 v6, s[24:27], s34 offen lds
    s_add_u32 s34, s34, s38
    v_mfma_f32_16x16x32_bf16 v[104:107], v[60:63], v[32:35], v[104:107]
    v_mfma_f32_16x16x32_bf16 v[120:123], v[60:63], v[36:39], v[120:123]
    s_waitcnt vmcnt(8) lgkmcnt(0)
    s_barrier
    v_mfma_f32_16x16x32_bf16 v[92:95], v[64:67], v[40:43], v[92:95]
    ds_read_b128 v[32:35], v8 offset:32768
    ds_read_b128 v[36:39], v8 offset:34816
    v_mfma_f32_16x16x32_bf16 v[108:111], v[64:67], v[44:47], v[108:111]
    ds_read_b64_tr_b16 v[48:49], v16 offset:32768
    ds_read_b64_tr_b16 v[50:51], v16 offset:33280
    v_mfma_f32_16x16x32_bf16 v[96:99], v[68:71], v[40:43], v[96:99]
    ds_read_b64_tr_b16 v[52:53], v17 offset:32768
    ds_read_b64_tr_b16 v[54:55], v17 offset:33280
    v_mfma_f32_16x16x32_bf16 v[112:115], v[68:71], v[44:47], v[112:115]
    ds_read_b64_tr_b16 v[56:57], v18 offset:32768
    ds_read_b64_tr_b16 v[58:59], v18 offset:33280
    v_mfma_f32_16x16x32_bf16 v[100:103], v[72:75], v[40:43], v[100:103]
    ds_read_b64_tr_b16 v[60:61], v19 offset:32768
    v_mfma_f32_16x16x32_bf16 v[116:119], v[72:75], v[44:47], v[116:119]
    ds_read_b64_tr_b16 v[62:63], v19 offset:33280
    v_mfma_f32_16x16x32_bf16 v[104:107], v[76:79], v[40:43], v[104:107]
    v_mfma_f32_16x16x32_bf16 v[120:123], v[76:79], v[44:47], v[120:123]
    s_waitcnt lgkmcnt(0)
    v_mfma_f32_16x16x32_bf16 v[92:95], v[48:51], v[32:35], v[92:95]
    ds_read_b128 v[40:43], v10 offset:32768
    ds_read_b128 v[44:47], v10 offset:34816
    ds_read_b64_tr_b16 v[64:65], v16 offset:36864
    v_mfma_f32_16x16x32_bf16 v[108:111], v[48:51], v[36:39], v[108:111]
    ds_read_b64_tr_b16 v[66:67], v16 offset:37376
    ds_read_b64_tr_b16 v[68:69], v17 offset:36864
    v_mfma_f32_16x16x32_bf16 v[96:99], v[52:55], v[32:35], v[96:99]
    ds_read_b64_tr_b16 v[70:71], v17 offset:37376
    ds_read_b64_tr_b16 v[72:73], v18 offset:36864
    v_mfma_f32_16x16x32_bf16 v[112:115], v[52:55], v[36:39], v[112:115]
    ds_read_b64_tr_b16 v[74:75], v18 offset:37376
    ds_read_b64_tr_b16 v[76:77], v19 offset:36864
    v_mfma_f32_16x16x32_bf16 v[100:103], v[56:59], v[32:35], v[100:103]
    ds_read_b64_tr_b16 v[78:79], v19 offset:37376
    s_add_u32 m0, s36, 65536
    s_nop 0
    buffer_load_dwordx4 v4, s[20:23], s35 offen lds
    buffer_load_dwordx4 v5, s[20:23], s35 offen offset:1024 lds
    s_add_u32 s35, s35, 128
    v_mfma_f32_16x16x32_bf16 v[116:119], v[56:59], v[36:39], v[116:119]
    s_add_u32 m0, s37, 65536
    s_nop 0
    buffer_load_dwordx4 v6, s[24:27], s34 offen lds
    s_add_u32 s34, s34, s38
    s_add_u32 m0, s37, 69632
    s_nop 0
    buffer_load_dwordx4 v6, s[24:27], s34 offen lds
    s_add_u32 s34, s34, s38
    v_mfma_f32_16x16x32_bf16 v[104:107], v[60:63], v[32:35], v[104:107]
    v_mfma_f32_16x16x32_bf16 v[120:123], v[60:63], v[36:39], v[120:123]
    s_waitcnt vmcnt(8) lgkmcnt(0)
    s_barrier
    v_mfma_f32_16x16x32_bf16 v[92:95], v[64:67], v[40:43], v[92:95]
    ds_read_b128 v[32:35], v7 offset:0
    ds_read_b128 v[36:39], v7 offset:2048
    v_mfma_f32_16x16x32_bf16 v[108:111], v[64:67], v[44:47], v[108:111]
    ds_read_b64_tr_b16 v[48:49], v12 offset:0
    ds_read_b64_tr_b16 v[50:51], v12 offset:512
    v_mfma_f32_16x16x32_bf16 v[96:99], v[68:71], v[40:43], v[96:99]
    ds_read_b64_tr_b16 v[52:53], v13 offset:0
    ds_read_b64_tr_b16 v[54:55], v13 offset:512
    v_mfma_f32_16x16x32_bf16 v[112:115], v[68:71], v[44:47], v[112:115]
    ds_read_b64_tr_b16 v[56:57], v14 offset:0
    ds_read_b64_tr_b16 v[58:59], v14 offset:512
    v_mfma_f32_16x16x32_bf16 v[100:103], v[72:75], v[40:43], v[100:103]
    ds_read_b64_tr_b16 v[60:61], v15 offset:0
    ds_read_b64_tr_b16 v[62:63], v15 offset:512
    v_mfma_f32_16x16x32_bf16 v[116:119], v[72:75], v[44:47], v[116:119]
    s_waitcnt vmcnt(20)
    v_readfirstlane_b32 s84, v200
    s_sub_i32 s85, s82, s84
    s_cmp_lt_i32 s85, 1500
    s_cselect_b32 s85, s84, 0
    s_cmp_lg_u32 s85, 0
    s_cbranch_scc1 tk_8
    v_mov_b32 v252, 0
    s_mov_b32 s93, 0
tok_9:
    global_load_dword v253, v252, s[56:57] sc1
    s_add_u32 s93, s93, 1
    s_waitcnt vmcnt(0)
    v_readfirstlane_b32 s84, v253
    s_cmp_ge_u32 s93, 0x4000
    s_cbranch_scc1 tok_10
    s_sub_i32 s85, s82, s84
    s_cmp_lt_i32 s85, 1500
    s_cselect_b32 s85, s84, 0
    s_cmp_lg_u32 s85, 0
    s_cbranch_scc0 tok_9
tok_10:
tk_8:
    v_mfma_f32_16x16x32_bf16 v[104:107], v[76:79], v[40:43], v[104:107]
    v_mfma_f32_16x16x32_bf16 v[120:123], v[76:79], v[44:47], v[120:123]
    s_waitcnt lgkmcnt(0)
    v_mfma_f32_16x16x32_bf16 v[92:95], v[48:51], v[32:35], v[92:95]
    ds_read_b128 v[40:43], v9 offset:0
    ds_read_b128 v[44:47], v9 offset:2048
    v_mfma_f32_16x16x32_bf16 v[108:111], v[48:51], v[36:39], v[108:111]
    ds_read_b64_tr_b16 v[64:65], v12 offset:4096
    ds_read_b64_tr_b16 v[66:67], v12 offset:4608
    v_mfma_f32_16x16x32_bf16 v[96:99], v[52:55], v[32:35], v[96:99]
    ds_read_b64_tr_b16 v[68:69], v13 offset:4096
    ds_read_b64_tr_b16 v[70:71], v13 offset:4608
    v_mfma_f32_16x16x32_bf16 v[112:115], v[52:55], v[36:39], v[112:115]
    ds_read_b64_tr_b16 v[72:73], v14 offset:4096
    ds_read_b64_tr_b16 v[74:75], v14 offset:4608
    v_mfma_f32_16x16x32_bf16 v[100:103], v[56:59], v[32:35], v[100:103]
    ds_read_b64_tr_b16 v[76:77], v15 offset:4096
    ds_read_b64_tr_b16 v[78:79], v15 offset:4608
    v_mfma_f32_16x16x32_bf16 v[116:119], v[56:59], v[36:39], v[116:119]
    s_lshl_b32 s60, s2, 3
    s_add_u32 s60, s60, s19
    s_lshl_b32 s60, s60, 10
    s_mov_b32 s72, s64
    s_and_b32 s73, s65, 0xffff
    s_mov_b32 s74, 401408
    s_mov_b32 s75, 0x00020000
    s_sub_u32 s61, s60, 0
    buffer_load_dwordx4 v[204:207], v240, s[72:75], s61 offen
    s_mov_b32 s72, s66
    s_and_b32 s73, s67, 0xffff
    s_mov_b32 s74, 1605632
    s_mov_b32 s75, 0x00020000
    s_sub_u32 s61, s60, 0
    buffer_load_dwordx4 v[204:207], v240, s[72:75], s61 offen
    s_mov_b32 s72, s62
    s_and_b32 s73, s63, 0xffff
    s_mov_b32 s74, 401408
    s_mov_b32 s75, 0x00020000
    s_sub_u32 s61, s60, 401408
    buffer_load_dwordx4 v[204:207], v240, s[72:75], s61 offen
    s_mov_b32 s72, s68
    s_and_b32 s73, s69, 0xffff
    s_mov_b32 s74, 1605632
    s_mov_b32 s75, 0x00020000
    s_sub_u32 s61, s60, 229376
    buffer_load_dwordx4 v[204:207], v240, s[72:75], s61 offen
    v_mfma_f32_16x16x32_bf16 v[104:107], v[60:63], v[32:35], v[104:107]
    v_mfma_f32_16x16x32_bf16 v[120:123], v[60:63], v[36:39], v[120:123]
    s_waitcnt vmcnt(8) lgkmcnt(0)
    s_barrier
    v_mfma_f32_16x16x32_bf16 v[92:95], v[64:67], v[40:43], v[92:95]
    ds_read_b128 v[32:35], v7 offset:32768
    ds_read_b128 v[36:39], v7 offset:34816
    v_mfma_f32_16x16x32_bf16 v[108:111], v[64:67], v[44:47], v[108:111]
    ds_read_b64_tr_b16 v[48:49], v12 offset:32768
    ds_read_b64_tr_b16 v[50:51], v12 offset:33280
    v_mfma_f32_16x16x32_bf16 v[96:99], v[68:71], v[40:43], v[96:99]
    ds_read_b64_tr_b16 v[52:53], v13 offset:32768
    ds_read_b64_tr_b16 v[54:55], v13 offset:33280
    v_mfma_f32_16x16x32_bf16 v[112:115], v[68:71], v[44:47], v[112:115]
    ds_read_b64_tr_b16 v[56:57], v14 offset:32768
    ds_read_b64_tr_b16 v[58:59], v14 offset:33280
    v_mfma_f32_16x16x32_bf16 v[100:103], v[72:75], v[40:43], v[100:103]
    ds_read_b64_tr_b16 v[60:61], v15 offset:32768
    v_mfma_f32_16x16x32_bf16 v[116:119], v[72:75], v[44:47], v[116:119]
    ds_read_b64_tr_b16 v[62:63], v15 offset:33280
    v_mfma_f32_16x16x32_bf16 v[104:107], v[76:79], v[40:43], v[104:107]
    v_mfma_f32_16x16x32_bf16 v[120:123], v[76:79], v[44:47], v[120:123]
    s_waitcnt lgkmcnt(0)
    v_mfma_f32_16x16x32_bf16 v[92:95], v[48:51], v[32:35], v[92:95]
    ds_read_b128 v[40:43], v9 offset:32768
    ds_read_b128 v[44:47], v9 offset:34816
    v_mfma_f32_16x16x32_bf16 v[108:111], v[48:51], v[36:39], v[108:111]
    ds_read_b64_tr_b16 v[64:65], v12 offset:36864
    ds_read_b64_tr_b16 v[66:67], v12 offset:37376
    v_mfma_f32_16x16x32_bf16 v[96:99], v[52:55], v[32:35], v[96:99]
    ds_read_b64_tr_b16 v[68:69], v13 offset:36864
    ds_read_b64_tr_b16 v[70:71], v13 offset:37376
    v_mfma_f32_16x16x32_bf16 v[112:115], v[52:55], v[36:39], v[112:115]
    ds_read_b64_tr_b16 v[72:73], v14 offset:36864
    ds_read_b64_tr_b16 v[74:75], v14 offset:37376
    v_mfma_f32_16x16x32_bf16 v[100:103], v[56:59], v[32:35], v[100:103]
    ds_read_b64_tr_b16 v[76:77], v15 offset:36864
    ds_read_b64_tr_b16 v[78:79], v15 offset:37376
    v_mfma_f32_16x16x32_bf16 v[116:119], v[56:59], v[36:39], v[116:119]
    s_mov_b32 s85, 11272192
    s_mov_b64 exec, 0x7
    buffer_load_dword v253, v201, s[28:31], s85 offen sc1
    s_mov_b64 exec, -1
    v_mfma_f32_16x16x32_bf16 v[104:107], v[60:63], v[32:35], v[104:107]
    v_mfma_f32_16x16x32_bf16 v[120:123], v[60:63], v[36:39], v[120:123]
    s_waitcnt vmcnt(5) lgkmcnt(0)
    s_barrier
    v_mfma_f32_16x16x32_bf16 v[92:95], v[64:67], v[40:43], v[92:95]
    ds_read_b128 v[32:35], v8 offset:0
    ds_read_b128 v[36:39], v8 offset:2048
    v_mfma_f32_16x16x32_bf16 v[108:111], v[64:67], v[44:47], v[108:111]
    ds_read_b64_tr_b16 v[48:49], v16 offset:0
    ds_read_b64_tr_b16 v[50:51], v16 offset:512
    v_mfma_f32_16x16x32_bf16 v[96:99], v[68:71], v[40:43], v[96:99]
    ds_read_b64_tr_b16 v[52:53], v17 offset:0
    ds_read_b64_tr_b16 v[54:55], v17 offset:512
    v_mfma_f32_16x16x32_bf16 v[112:115], v[68:71], v[44:47], v[112:115]
    ds_read_b64_tr_b16 v[56:57], v18 offset:0
    ds_read_b64_tr_b16 v[58:59], v18 offset:512
    v_mfma_f32_16x16x32_bf16 v[100:103], v[72:75], v[40:43], v[100:103]
    ds_read_b64_tr_b16 v[60:61], v19 offset:0
    v_mfma_f32_16x16x32_bf16 v[116:119], v[72:75], v[44:47], v[116:119]
    ds_read_b64_tr_b16 v[62:63], v19 offset:512
    v_mfma_f32_16x16x32_bf16 v[104:107], v[76:79], v[40:43], v[104:107]
    v_mfma_f32_16x16x32_bf16 v[120:123], v[76:79], v[44:47], v[120:123]
    s_waitcnt lgkmcnt(0)
    v_mfma_f32_16x16x32_bf16 v[92:95], v[48:51], v[32:35], v[92:95]
    ds_read_b128 v[40:43], v10 offset:0
    ds_read_b128 v[44:47], v10 offset:2048
    v_mfma_f32_16x16x32_bf16 v[108:111], v[48:51], v[36:39], v[108:111]
    ds_read_b64_tr_b16 v[64:65], v16 offset:4096
    ds_read_b64_tr_b16 v[66:67], v16 offset:4608
    v_mfma_f32_16x16x32_bf16 v[96:99], v[52:55], v[32:35], v[96:99]
    ds_read_b64_tr_b16 v[68:69], v17 offset:4096
    ds_read_b64_tr_b16 v[70:71], v17 offset:4608
    v_mfma_f32_16x16x32_bf16 v[112:115], v[52:55], v[36:39], v[112:115]
    ds_read_b64_tr_b16 v[72:73], v18 offset:4096
    ds_read_b64_tr_b16 v[74:75], v18 offset:4608
    v_mfma_f32_16x16x32_bf16 v[100:103], v[56:59], v[32:35], v[100:103]
    ds_read_b64_tr_b16 v[76:77], v19 offset:4096
    ds_read_b64_tr_b16 v[78:79], v19 offset:4608
    v_mfma_f32_16x16x32_bf16 v[116:119], v[56:59], v[36:39], v[116:119]
    s_waitcnt vmcnt(0)
    v_cmp_ne_u32 s[96:97], s84, v253
    buffer_load_dwordx2 v[180:181], v202, s[28:31], s44 offen offset:0 sc1
    buffer_load_dwordx2 v[182:183], v202, s[28:31], s44 offen offset:128 sc1
    buffer_load_dwordx4 v[164:167], v243, s[28:31], s45 offen offset:0 sc1
    buffer_load_dwordx4 v[168:171], v203, s[28:31], s45 offen offset:0 sc1
    buffer_load_dwordx4 v[172:175], v243, s[28:31], s45 offen offset:128 sc1
    buffer_load_dwordx4 v[176:179], v203, s[28:31], s45 offen offset:128 sc1
    v_mfma_f32_16x16x32_bf16 v[104:107], v[60:63], v[32:35], v[104:107]
    v_mfma_f32_16x16x32_bf16 v[120:123], v[60:63], v[36:39], v[120:123]
    s_waitcnt lgkmcnt(0)
    v_mfma_f32_16x16x32_bf16 v[92:95], v[64:67], v[40:43], v[92:95]
    v_mfma_f32_16x16x32_bf16 v[108:111], v[64:67], v[44:47], v[108:111]
    v_mfma_f32_16x16x32_bf16 v[96:99], v[68:71], v[40:43], v[96:99]
    v_mfma_f32_16x16x32_bf16 v[112:115], v[68:71], v[44:47], v[112:115]
    v_mfma_f32_16x16x32_bf16 v[100:103], v[72:75], v[40:43], v[100:103]
    v_mfma_f32_16x16x32_bf16 v[116:119], v[72:75], v[44:47], v[116:119]
    v_mfma_f32_16x16x32_bf16 v[104:107], v[76:79], v[40:43], v[104:107]
    v_mfma_f32_16x16x32_bf16 v[120:123], v[76:79], v[44:47], v[120:123]
    s_and_b64 s[96:97], s[96:97], 0x7
    s_cbranch_scc0 spec_11
    s_mov_b64 exec, 0x7
    s_mov_b32 s85, 11272192
    s_mov_b32 s93, 0
pol_12:
    buffer_load_dword v253, v201, s[28:31], s85 offen sc1
    s_add_u32 s93, s93, 1
    s_waitcnt vmcnt(0)
    v_cmp_ne_u32 vcc, s84, v253
    s_cmp_lt_u32 s93, 0x20000
    s_cselect_b64 s[94:95], vcc, 0
    s_cmp_lg_u64 s[94:95], 0
    s_cbranch_scc1 pol_12
    s_mov_b64 exec, -1
    buffer_load_dwordx2 v[180:181], v202, s[28:31], s44 offen offset:0 sc1
    buffer_load_dwordx2 v[182:183], v202, s[28:31], s44 offen offset:128 sc1
    buffer_load_dwordx4 v[164:167], v243, s[28:31], s45 offen offset:0 sc1
    buffer_load_dwordx4 v[168:171], v203, s[28:31], s45 offen offset:0 sc1
    buffer_load_dwordx4 v[172:175], v243, s[28:31], s45 offen offset:128 sc1
    buffer_load_dwordx4 v[176:179], v203, s[28:31], s45 offen offset:128 sc1
    s_waitcnt vmcnt(0)
spec_11:
    s_waitcnt vmcnt(0)
    v_rcp_f32 v146, v181
    v_mul_f32 v142, 0xc0135761, v181
    v_mul_f32 v144, v181, v181
    v_mul_f32 v144, v144, v181
    v_mul_f32 v144, 0xbdd2d3e8, v144
    v_mov_b32 v140, v180
    v_mov_b32 v141, v140
    v_mov_b32 v143, v142
    v_mov_b32 v145, v144
    v_mov_b32 v147, v146
    v_rcp_f32 v154, v183
    v_mul_f32 v150, 0xc0135761, v183
    v_mul_f32 v152, v183, v183
    v_mul_f32 v152, v152, v183
    v_mul_f32 v152, 0xbdd2d3e8, v152
    v_mov_b32 v148, v182
    v_mov_b32 v149, v148
    v_mov_b32 v151, v150
    v_mov_b32 v153, v152
    v_mov_b32 v155, v154
    v_pk_fma_f32 v[92:93], v[164:165], v[140:141], v[92:93]
    v_pk_fma_f32 v[94:95], v[166:167], v[140:141], v[94:95]
    v_pk_fma_f32 v[96:97], v[168:169], v[140:141], v[96:97]
    v_pk_fma_f32 v[98:99], v[170:171], v[140:141], v[98:99]
    v_pk_fma_f32 v[100:101], v[172:173], v[140:141], v[100:101]
    v_pk_fma_f32 v[102:103], v[174:175], v[140:141], v[102:103]
    v_pk_fma_f32 v[104:105], v[176:177], v[140:141], v[104:105]
    v_pk_fma_f32 v[106:107], v[178:179], v[140:141], v[106:107]
    v_pk_mul_f32 v[48:49], v[92:93], v[92:93]
    v_pk_mul_f32 v[50:51], v[94:95], v[94:95]
    v_pk_mul_f32 v[52:53], v[96:97], v[96:97]
    v_pk_mul_f32 v[54:55], v[98:99], v[98:99]
    v_pk_mul_f32 v[56:57], v[100:101], v[100:101]
    v_pk_mul_f32 v[58:59], v[102:103], v[102:103]
    v_pk_mul_f32 v[60:61], v[104:105], v[104:105]
    v_pk_mul_f32 v[62:63], v[106:107], v[106:107]
    v_pk_fma_f32 v[48:49], v[48:49], v[144:145], v[142:143]
    v_pk_fma_f32 v[50:51], v[50:51], v[144:145], v[142:143]
    v_pk_fma_f32 v[52:53], v[52:53], v[144:145], v[142:143]
    v_pk_fma_f32 v[54:55], v[54:55], v[144:145], v[142:143]
    v_pk_fma_f32 v[56:57], v[56:57], v[144:145], v[142:143]
    v_pk_fma_f32 v[58:59], v[58:59], v[144:145], v[142:143]
    v_pk_fma_f32 v[60:61], v[60:61], v[144:145], v[142:143]
    v_pk_fma_f32 v[62:63], v[62:63], v[144:145], v[142:143]
    v_pk_mul_f32 v[48:49], v[48:49], v[92:93]
    v_pk_mul_f32 v[50:51], v[50:51], v[94:95]
    v_pk_mul_f32 v[52:53], v[52:53], v[96:97]
    v_pk_mul_f32 v[54:55], v[54:55], v[98:99]
    v_pk_mul_f32 v[56:57], v[56:57], v[100:101]
    v_pk_mul_f32 v[58:59], v[58:59], v[102:103]
    v_pk_mul_f32 v[60:61], v[60:61], v[104:105]
    v_pk_mul_f32 v[62:63], v[62:63], v[106:107]
    v_exp_f32 v48, v48
    v_exp_f32 v49, v49
    v_exp_f32 v50, v50
    v_exp_f32 v51, v51
    v_exp_f32 v52, v52
    v_exp_f32 v53, v53
    v_exp_f32 v54, v54
    v_exp_f32 v55, v55
    v_exp_f32 v56, v56
    v_exp_f32 v57, v57
    v_exp_f32 v58, v58
    v_exp_f32 v59, v59
    v_exp_f32 v60, v60
    v_exp_f32 v61, v61
    v_exp_f32 v62, v62
    v_exp_f32 v63, v63
    v_pk_fma_f32 v[48:49], v[48:49], v[146:147], v[146:147]
    v_pk_fma_f32 v[50:51], v[50:51], v[146:147], v[146:147]
    v_pk_fma_f32 v[52:53], v[52:53], v[146:147], v[146:147]
    v_pk_fma_f32 v[54:55], v[54:55], v[146:147], v[146:147]
    v_pk_fma_f32 v[56:57], v[56:57], v[146:147], v[146:147]
    v_pk_fma_f32 v[58:59], v[58:59], v[146:147], v[146:147]
    v_pk_fma_f32 v[60:61], v[60:61], v[146:147], v[146:147]
    v_pk_fma_f32 v[62:63], v[62:63], v[146:147], v[146:147]
    v_rcp_f32 v48, v48
    v_rcp_f32 v49, v49
    v_rcp_f32 v50, v50
    v_rcp_f32 v51, v51
    v_rcp_f32 v52, v52
    v_rcp_f32 v53, v53
    v_rcp_f32 v54, v54
    v_rcp_f32 v55, v55
    v_rcp_f32 v56, v56
    v_rcp_f32 v57, v57
    v_rcp_f32 v58, v58
    v_rcp_f32 v59, v59
    v_rcp_f32 v60, v60
    v_rcp_f32 v61, v61
    v_rcp_f32 v62, v62
    v_rcp_f32 v63, v63
    v_pk_mul_f32 v[92:93], v[92:93], v[48:49]
    v_pk_mul_f32 v[94:95], v[94:95], v[50:51]
    v_pk_mul_f32 v[96:97], v[96:97], v[52:53]
    v_pk_mul_f32 v[98:99], v[98:99], v[54:55]
    v_pk_mul_f32 v[100:101], v[100:101], v[56:57]
    v_pk_mul_f32 v[102:103], v[102:103], v[58:59]
    v_pk_mul_f32 v[104:105], v[104:105], v[60:61]
    v_pk_mul_f32 v[106:107], v[106:107], v[62:63]
    v_cvt_pk_bf16_f32 v32, v92, v93
    v_cvt_pk_bf16_f32 v33, v94, v95
    v_cvt_pk_bf16_f32 v34, v96, v97
    v_cvt_pk_bf16_f32 v35, v98, v99
    v_cvt_pk_bf16_f32 v36, v100, v101
    v_cvt_pk_bf16_f32 v37, v102, v103
    v_cvt_pk_bf16_f32 v38, v104, v105
    v_cvt_pk_bf16_f32 v39, v106, v107
    buffer_store_dwordx4 v[32:35], v184, s[52:55], 0 offen sc1
    buffer_store_dwordx4 v[36:39], v185, s[52:55], 0 offen sc1
    v_pk_fma_f32 v[108:109], v[164:165], v[148:149], v[108:109]
    v_pk_fma_f32 v[110:111], v[166:167], v[148:149], v[110:111]
    v_pk_fma_f32 v[112:113], v[168:169], v[148:149], v[112:113]
    v_pk_fma_f32 v[114:115], v[170:171], v[148:149], v[114:115]
    v_pk_fma_f32 v[116:117], v[172:173], v[148:149], v[116:117]
    v_pk_fma_f32 v[118:119], v[174:175], v[148:149], v[118:119]
    v_pk_fma_f32 v[120:121], v[176:177], v[148:149], v[120:121]
    v_pk_fma_f32 v[122:123], v[178:179], v[148:149], v[122:123]
    v_pk_mul_f32 v[48:49], v[108:109], v[108:109]
    v_pk_mul_f32 v[50:51], v[110:111], v[110:111]
    v_pk_mul_f32 v[52:53], v[112:113], v[112:113]
    v_pk_mul_f32 v[54:55], v[114:115], v[114:115]
    v_pk_mul_f32 v[56:57], v[116:117], v[116:117]
    v_pk_mul_f32 v[58:59], v[118:119], v[118:119]
    v_pk_mul_f32 v[60:61], v[120:121], v[120:121]
    v_pk_mul_f32 v[62:63], v[122:123], v[122:123]
    v_pk_fma_f32 v[48:49], v[48:49], v[152:153], v[150:151]
    v_pk_fma_f32 v[50:51], v[50:51], v[152:153], v[150:151]
    v_pk_fma_f32 v[52:53], v[52:53], v[152:153], v[150:151]
    v_pk_fma_f32 v[54:55], v[54:55], v[152:153], v[150:151]
    v_pk_fma_f32 v[56:57], v[56:57], v[152:153], v[150:151]
    v_pk_fma_f32 v[58:59], v[58:59], v[152:153], v[150:151]
    v_pk_fma_f32 v[60:61], v[60:61], v[152:153], v[150:151]
    v_pk_fma_f32 v[62:63], v[62:63], v[152:153], v[150:151]
    v_pk_mul_f32 v[48:49], v[48:49], v[108:109]
    v_pk_mul_f32 v[50:51], v[50:51], v[110:111]
    v_pk_mul_f32 v[52:53], v[52:53], v[112:113]
    v_pk_mul_f32 v[54:55], v[54:55], v[114:115]
    v_pk_mul_f32 v[56:57], v[56:57], v[116:117]
    v_pk_mul_f32 v[58:59], v[58:59], v[118:119]
    v_pk_mul_f32 v[60:61], v[60:61], v[120:121]
    v_pk_mul_f32 v[62:63], v[62:63], v[122:123]
    v_exp_f32 v48, v48
    v_exp_f32 v49, v49
    v_exp_f32 v50, v50
    v_exp_f32 v51, v51
    v_exp_f32 v52, v52
    v_exp_f32 v53, v53
    v_exp_f32 v54, v54
    v_exp_f32 v55, v55
    v_exp_f32 v56, v56
    v_exp_f32 v57, v57
    v_exp_f32 v58, v58
    v_exp_f32 v59, v59
    v_exp_f32 v60, v60
    v_exp_f32 v61, v61
    v_exp_f32 v62, v62
    v_exp_f32 v63, v63
    v_pk_fma_f32 v[48:49], v[48:49], v[154:155], v[154:155]
    v_pk_fma_f32 v[50:51], v[50:51], v[154:155], v[154:155]
    v_pk_fma_f32 v[52:53], v[52:53], v[154:155], v[154:155]
    v_pk_fma_f32 v[54:55], v[54:55], v[154:155], v[154:155]
    v_pk_fma_f32 v[56:57], v[56:57], v[154:155], v[154:155]
    v_pk_fma_f32 v[58:59], v[58:59], v[154:155], v[154:155]
    v_pk_fma_f32 v[60:61], v[60:61], v[154:155], v[154:155]
    v_pk_fma_f32 v[62:63], v[62:63], v[154:155], v[154:155]
    v_rcp_f32 v48, v48
    v_rcp_f32 v49, v49
    v_rcp_f32 v50, v50
    v_rcp_f32 v51, v51
    v_rcp_f32 v52, v52
    v_rcp_f32 v53, v53
    v_rcp_f32 v54, v54
    v_rcp_f32 v55, v55
    v_rcp_f32 v56, v56
    v_rcp_f32 v57, v57
    v_rcp_f32 v58, v58
    v_rcp_f32 v59, v59
    v_rcp_f32 v60, v60
    v_rcp_f32 v61, v61
    v_rcp_f32 v62, v62
    v_rcp_f32 v63, v63
    v_pk_mul_f32 v[108:109], v[108:109], v[48:49]
    v_pk_mul_f32 v[110:111], v[110:111], v[50:51]
    v_pk_mul_f32 v[112:113], v[112:113], v[52:53]
    v_pk_mul_f32 v[114:115], v[114:115], v[54:55]
    v_pk_mul_f32 v[116:117], v[116:117], v[56:57]
    v_pk_mul_f32 v[118:119], v[118:119], v[58:59]
    v_pk_mul_f32 v[120:121], v[120:121], v[60:61]
    v_pk_mul_f32 v[122:123], v[122:123], v[62:63]
    v_cvt_pk_bf16_f32 v40, v108, v109
    v_cvt_pk_bf16_f32 v41, v110, v111
    v_cvt_pk_bf16_f32 v42, v112, v113
    v_cvt_pk_bf16_f32 v43, v114, v115
    v_cvt_pk_bf16_f32 v44, v116, v117
    v_cvt_pk_bf16_f32 v45, v118, v119
    v_cvt_pk_bf16_f32 v46, v120, v121
    v_cvt_pk_bf16_f32 v47, v122, v123
    buffer_store_dwordx4 v[40:43], v186, s[52:55], 0 offen sc1
    buffer_store_dwordx4 v[44:47], v187, s[52:55], 0 offen sc1
    s_branch p1_done
helper:
    s_load_dwordx2 s[10:11], s[0:1], 64
    s_load_dwordx2 s[12:13], s[0:1], 48
    s_sub_u32 s14, s2, 224
    v_mov_b32 v236, 0
    v_mov_b32 v237, 0
    v_mov_b32 v238, 0
    v_mov_b32 v239, 0
    v_mov_b32 v241, 0
    v_mov_b32 v242, 0
    v_mov_b32 v243, 0
    v_lshrrev_b32 v4, 3, v1
    v_and_b32 v5, 7, v1
    v_lshlrev_b32 v5, 4, v5
    s_lshl_b32 s15, s14, 6
    s_lshl_b32 s16, s19, 3
    s_add_u32 s15, s15, s16
    v_add_u32 v4, s15, v4
    v_mul_u32_u24 v6, 896, v4
    v_add_u32 v6, v6, v5
    s_waitcnt lgkmcnt(0)
    s_mov_b32 s20, s4
    s_and_b32 s21, s5, 0xffff
    s_mov_b32 s22, 1835008
    s_mov_b32 s23, 0x00020000
    s_mov_b32 s28, s58
    s_and_b32 s29, s59, 0xffff
    s_mov_b32 s30, 33554432
    s_mov_b32 s31, 0x00020000
    s_mov_b32 s48, s10
    s_and_b32 s49, s11, 0xffff
    s_mov_b32 s50, 896
    s_mov_b32 s51, 0x00020000
    buffer_load_dwordx4 v[8:11], v6, s[20:23], 0 offen offset:0
    buffer_load_dwordx4 v[12:15], v6, s[20:23], 0 offen offset:128
    buffer_load_dwordx4 v[16:19], v6, s[20:23], 0 offen offset:256
    buffer_load_dwordx4 v[20:23], v6, s[20:23], 0 offen offset:384
    buffer_load_dwordx4 v[24:27], v6, s[20:23], 0 offen offset:512
    buffer_load_dwordx4 v[28:31], v6, s[20:23], 0 offen offset:640
    buffer_load_dwordx4 v[32:35], v6, s[20:23], 0 offen offset:768
    v_lshrrev_b32 v7, 3, v1
    s_cmp_lt_u32 s14, 7
    s_cselect_b32 s24, s8, s12
    s_cselect_b32 s25, s9, s13
    s_movk_i32 s32, 896
    s_cselect_b32 s32, s32, 3584
    s_cselect_b32 s33, 0, 7
    s_mov_b32 s26, 1605632
    s_cselect_b32 s26, 401408, s26
    s_and_b32 s25, s25, 0xffff
    s_mov_b32 s27, 0x00020000
    s_sub_u32 s33, s14, s33
    s_lshl_b32 s33, s33, 7
    s_mul_i32 s34, s19, 56
    s_mul_i32 s34, s34, s32
    s_add_u32 s33, s33, s34
    v_mul_lo_u32 v130, v7, s32
    v_add_u32 v130, v130, v5
    s_lshl_b32 s32, s32, 3
    buffer_load_dwordx4 v[132:135], v130, s[24:27], s33 offen
    s_add_u32 s33, s33, s32
    buffer_load_dwordx4 v[136:139], v130, s[24:27], s33 offen
    s_add_u32 s33, s33, s32
    buffer_load_dwordx4 v[140:143], v130, s[24:27], s33 offen
    s_add_u32 s33, s33, s32
    buffer_load_dwordx4 v[144:147], v130, s[24:27], s33 offen
    s_add_u32 s33, s33, s32
    buffer_load_dwordx4 v[148:151], v130, s[24:27], s33 offen
    s_add_u32 s33, s33, s32
    buffer_load_dwordx4 v[152:155], v130, s[24:27], s33 offen
    s_add_u32 s33, s33, s32
    buffer_load_dwordx4 v[156:159], v130, s[24:27], s33 offen
    s_add_u32 s33, s33, s32
    buffer_load_dwordx4 v[40:43], v5, s[48:51], 0 offen offset:0
    buffer_load_dwordx4 v[44:47], v5, s[48:51], 0 offen offset:128
    buffer_load_dwordx4 v[48:51], v5, s[48:51], 0 offen offset:256
    buffer_load_dwordx4 v[52:55], v5, s[48:51], 0 offen offset:384
    buffer_load_dwordx4 v[56:59], v5, s[48:51], 0 offen offset:512
    buffer_load_dwordx4 v[60:63], v5, s[48:51], 0 offen offset:640
    buffer_load_dwordx4 v[64:67], v5, s[48:51], 0 offen offset:768
    s_lshl_b32 s33, s14, 3
    s_add_u32 s33, s33, s19
    s_lshl_b32 s33, s33, 11
    s_add_u32 s33, s33, 11272192
    buffer_load_dwordx4 v[204:207], v240, s[28:31], s33 offen offset:0
    buffer_load_dwordx4 v[204:207], v240, s[28:31], s33 offen offset:1024
    s_or_b32 s85, s14, s19
    s_cmp_lg_u32 s85, 0
    s_cbranch_scc1 tok_13
    s_or_b32 s85, s82, 1
    v_mov_b32 v252, 0
    v_mov_b32 v253, s85
    s_mov_b64 exec, 1
    global_store_dword v252, v253, s[56:57] sc1
    s_mov_b64 exec, -1
tok_13:
    s_waitcnt vmcnt(16)
    v_lshlrev_b32 v72, 16, v8
    v_and_b32 v73, 0xffff0000, v8
    v_lshlrev_b32 v74, 16, v9
    v_and_b32 v75, 0xffff0000, v9
    v_lshlrev_b32 v76, 16, v10
    v_and_b32 v77, 0xffff0000, v10
    v_lshlrev_b32 v78, 16, v11
    v_and_b32 v79, 0xffff0000, v11
    v_lshlrev_b32 v80, 16, v12
    v_and_b32 v81, 0xffff0000, v12
    v_lshlrev_b32 v82, 16, v13
    v_and_b32 v83, 0xffff0000, v13
    v_lshlrev_b32 v84, 16, v14
    v_and_b32 v85, 0xffff0000, v14
    v_lshlrev_b32 v86, 16, v15
    v_and_b32 v87, 0xffff0000, v15
    v_lshlrev_b32 v88, 16, v16
    v_and_b32 v89, 0xffff0000, v16
    v_lshlrev_b32 v90, 16, v17
    v_and_b32 v91, 0xffff0000, v17
    v_lshlrev_b32 v92, 16, v18
    v_and_b32 v93, 0xffff0000, v18
    v_lshlrev_b32 v94, 16, v19
    v_and_b32 v95, 0xffff0000, v19
    v_lshlrev_b32 v96, 16, v20
    v_and_b32 v97, 0xffff0000, v20
    v_lshlrev_b32 v98, 16, v21
    v_and_b32 v99, 0xffff0000, v21
    v_lshlrev_b32 v100, 16, v22
    v_and_b32 v101, 0xffff0000, v22
    v_lshlrev_b32 v102, 16, v23
    v_and_b32 v103, 0xffff0000, v23
    v_lshlrev_b32 v104, 16, v24
    v_and_b32 v105, 0xffff0000, v24
    v_lshlrev_b32 v106, 16, v25
    v_and_b32 v107, 0xffff0000, v25
    v_lshlrev_b32 v108, 16, v26
    v_and_b32 v109, 0xffff0000, v26
    v_lshlrev_b32 v110, 16, v27
    v_and_b32 v111, 0xffff0000, v27
    v_lshlrev_b32 v112, 16, v28
    v_and_b32 v113, 0xffff0000, v28
    v_lshlrev_b32 v114, 16, v29
    v_and_b32 v115, 0xffff0000, v29
    v_lshlrev_b32 v116, 16, v30
    v_and_b32 v117, 0xffff0000, v30
    v_lshlrev_b32 v118, 16, v31
    v_and_b32 v119, 0xffff0000, v31
    v_lshlrev_b32 v120, 16, v32
    v_and_b32 v121, 0xffff0000, v32
    v_lshlrev_b32 v122, 16, v33
    v_and_b32 v123, 0xffff0000, v33
    v_lshlrev_b32 v124, 16, v34
    v_and_b32 v125, 0xffff0000, v34
    v_lshlrev_b32 v126, 16, v35
    v_and_b32 v127, 0xffff0000, v35
    v_pk_add_f32 v[128:129], v[72:73], v[74:75]
    v_pk_add_f32 v[128:129], v[128:129], v[76:77]
    v_pk_add_f32 v[128:129], v[128:129], v[78:79]
    v_pk_add_f32 v[128:129], v[128:129], v[80:81]
    v_pk_add_f32 v[128:129], v[128:129], v[82:83]
    v_pk_add_f32 v[128:129], v[128:129], v[84:85]
    v_pk_add_f32 v[128:129], v[128:129], v[86:87]
    v_pk_add_f32 v[128:129], v[128:129], v[88:89]
    v_pk_add_f32 v[128:129], v[128:129], v[90:91]
    v_pk_add_f32 v[128:129], v[128:129], v[92:93]
    v_pk_add_f32 v[128:129], v[128:129], v[94:95]
    v_pk_add_f32 v[128:129], v[128:129], v[96:97]
    v_pk_add_f32 v[128:129], v[128:129], v[98:99]
    v_pk_add_f32 v[128:129], v[128:129], v[100:101]
    v_pk_add_f32 v[128:129], v[128:129], v[102:103]
    v_pk_add_f32 v[128:129], v[128:129], v[104:105]
    v_pk_add_f32 v[128:129], v[128:129], v[106:107]
    v_pk_add_f32 v[128:129], v[128:129], v[108:109]
    v_pk_add_f32 v[128:129], v[128:129], v[110:111]
    v_pk_add_f32 v[128:129], v[128:129], v[112:113]
    v_pk_add_f32 v[128:129], v[128:129], v[114:115]
    v_pk_add_f32 v[128:129], v[128:129], v[116:117]
    v_pk_add_f32 v[128:129], v[128:129], v[118:119]
    v_pk_add_f32 v[128:129], v[128:129], v[120:121]
    v_pk_add_f32 v[128:129], v[128:129], v[122:123]
    v_pk_add_f32 v[128:129], v[128:129], v[124:125]
    v_pk_add_f32 v[128:129], v[128:129], v[126:127]
    v_add_f32 v128, v128, v129
    s_nop 1
    v_add_f32_dpp v128, v128, v128 quad_perm:[1,0,3,2] row_mask:0xf bank_mask:0xf
    s_nop 1
    v_add_f32_dpp v128, v128, v128 quad_perm:[2,3,0,1] row_mask:0xf bank_mask:0xf
    s_nop 1
    v_add_f32_dpp v128, v128, v128 row_half_mirror row_mask:0xf bank_mask:0xf
    v_mul_f32 v128, 0x3b124925, v128
    v_sub_f32 v172, 0, v128
    v_mov_b32 v173, v172
    v_pk_add_f32 v[174:175], v[72:73], v[172:173]
    v_pk_mul_f32 v[182:183], v[174:175], v[174:175]
    v_pk_add_f32 v[176:177], v[74:75], v[172:173]
    v_pk_fma_f32 v[182:183], v[176:177], v[176:177], v[182:183]
    v_pk_add_f32 v[178:179], v[76:77], v[172:173]
    v_pk_fma_f32 v[182:183], v[178:179], v[178:179], v[182:183]
    v_pk_add_f32 v[180:181], v[78:79], v[172:173]
    v_pk_fma_f32 v[182:183], v[180:181], v[180:181], v[182:183]
    v_pk_add_f32 v[174:175], v[80:81], v[172:173]
    v_pk_fma_f32 v[182:183], v[174:175], v[174:175], v[182:183]
    v_pk_add_f32 v[176:177], v[82:83], v[172:173]
    v_pk_fma_f32 v[182:183], v[176:177], v[176:177], v[182:183]
    v_pk_add_f32 v[178:179], v[84:85], v[172:173]
    v_pk_fma_f32 v[182:183], v[178:179], v[178:179], v[182:183]
    v_pk_add_f32 v[180:181], v[86:87], v[172:173]
    v_pk_fma_f32 v[182:183], v[180:181], v[180:181], v[182:183]
    v_pk_add_f32 v[174:175], v[88:89], v[172:173]
    v_pk_fma_f32 v[182:183], v[174:175], v[174:175], v[182:183]
    v_pk_add_f32 v[176:177], v[90:91], v[172:173]
    v_pk_fma_f32 v[182:183], v[176:177], v[176:177], v[182:183]
    v_pk_add_f32 v[178:179], v[92:93], v[172:173]
    v_pk_fma_f32 v[182:183], v[178:179], v[178:179], v[182:183]
    v_pk_add_f32 v[180:181], v[94:95], v[172:173]
    v_pk_fma_f32 v[182:183], v[180:181], v[180:181], v[182:183]
    v_pk_add_f32 v[174:175], v[96:97], v[172:173]
    v_pk_fma_f32 v[182:183], v[174:175], v[174:175], v[182:183]
    v_pk_add_f32 v[176:177], v[98:99], v[172:173]
    v_pk_fma_f32 v[182:183], v[176:177], v[176:177], v[182:183]
    v_pk_add_f32 v[178:179], v[100:101], v[172:173]
    v_pk_fma_f32 v[182:183], v[178:179], v[178:179], v[182:183]
    v_pk_add_f32 v[180:181], v[102:103], v[172:173]
    v_pk_fma_f32 v[182:183], v[180:181], v[180:181], v[182:183]
    v_pk_add_f32 v[174:175], v[104:105], v[172:173]
    v_pk_fma_f32 v[182:183], v[174:175], v[174:175], v[182:183]
    v_pk_add_f32 v[176:177], v[106:107], v[172:173]
    v_pk_fma_f32 v[182:183], v[176:177], v[176:177], v[182:183]
    v_pk_add_f32 v[178:179], v[108:109], v[172:173]
    v_pk_fma_f32 v[182:183], v[178:179], v[178:179], v[182:183]
    v_pk_add_f32 v[180:181], v[110:111], v[172:173]
    v_pk_fma_f32 v[182:183], v[180:181], v[180:181], v[182:183]
    v_pk_add_f32 v[174:175], v[112:113], v[172:173]
    v_pk_fma_f32 v[182:183], v[174:175], v[174:175], v[182:183]
    v_pk_add_f32 v[176:177], v[114:115], v[172:173]
    v_pk_fma_f32 v[182:183], v[176:177], v[176:177], v[182:183]
    v_pk_add_f32 v[178:179], v[116:117], v[172:173]
    v_pk_fma_f32 v[182:183], v[178:179], v[178:179], v[182:183]
    v_pk_add_f32 v[180:181], v[118:119], v[172:173]
    v_pk_fma_f32 v[182:183], v[180:181], v[180:181], v[182:183]
    v_pk_add_f32 v[174:175], v[120:121], v[172:173]
    v_pk_fma_f32 v[182:183], v[174:175], v[174:175], v[182:183]
    v_pk_add_f32 v[176:177], v[122:123], v[172:173]
    v_pk_fma_f32 v[182:183], v[176:177], v[176:177], v[182:183]
    v_pk_add_f32 v[178:179], v[124:125], v[172:173]
    v_pk_fma_f32 v[182:183], v[178:179], v[178:179], v[182:183]
    v_pk_add_f32 v[180:181], v[126:127], v[172:173]
    v_pk_fma_f32 v[182:183], v[180:181], v[180:181], v[182:183]
    v_add_f32 v129, v182, v183
    s_nop 1
    v_add_f32_dpp v129, v129, v129 quad_perm:[1,0,3,2] row_mask:0xf bank_mask:0xf
    s_nop 1
    v_add_f32_dpp v129, v129, v129 quad_perm:[2,3,0,1] row_mask:0xf bank_mask:0xf
    s_nop 1
    v_add_f32_dpp v129, v129, v129 row_half_mirror row_mask:0xf bank_mask:0xf
    v_mul_f32 v129, 0x3b124925, v129
    v_cvt_pk_bf16_f32 v128, 0, v128
    v_cvt_pk_bf16_f32 v129, 0, v129
    v_add_f32 v129, 0x3727c5ac, v129
    v_cvt_pk_bf16_f32 v129, 0, v129
    v_sqrt_f32 v129, v129
    v_sub_f32 v128, 0, v128
    v_cvt_pk_bf16_f32 v129, 0, v129
    v_rcp_f32 v129, v129
    s_nop 0
    v_lshlrev_b32 v170, 3, v4
    s_mov_b32 s33, 11681792
    s_mov_b32 exec_lo, 0x01010101
    s_mov_b32 exec_hi, 0x01010101
    buffer_store_dwordx2 v[128:129], v170, s[28:31], s33 offen sc1
    s_mov_b64 exec, -1
    s_waitcnt vmcnt(10)
    v_lshlrev_b32 v160, 16, v132
    v_and_b32 v161, 0xffff0000, v132
    v_lshlrev_b32 v162, 16, v133
    v_and_b32 v163, 0xffff0000, v133
    v_lshlrev_b32 v164, 16, v134
    v_and_b32 v165, 0xffff0000, v134
    v_lshlrev_b32 v166, 16, v135
    v_and_b32 v167, 0xffff0000, v135
    v_lshlrev_b32 v168, 16, v136
    v_and_b32 v169, 0xffff0000, v136
    v_pk_add_f32 v[160:161], v[160:161], v[168:169]
    v_lshlrev_b32 v168, 16, v137
    v_and_b32 v169, 0xffff0000, v137
    v_pk_add_f32 v[162:163], v[162:163], v[168:169]
    v_lshlrev_b32 v168, 16, v138
    v_and_b32 v169, 0xffff0000, v138
    v_pk_add_f32 v[164:165], v[164:165], v[168:169]
    v_lshlrev_b32 v168, 16, v139
    v_and_b32 v169, 0xffff0000, v139
    v_pk_add_f32 v[166:167], v[166:167], v[168:169]
    v_lshlrev_b32 v168, 16, v140
    v_and_b32 v169, 0xffff0000, v140
    v_pk_add_f32 v[160:161], v[160:161], v[168:169]
    v_lshlrev_b32 v168, 16, v141
    v_and_b32 v169, 0xffff0000, v141
    v_pk_add_f32 v[162:163], v[162:163], v[168:169]
    v_lshlrev_b32 v168, 16, v142
    v_and_b32 v169, 0xffff0000, v142
    v_pk_add_f32 v[164:165], v[164:165], v[168:169]
    v_lshlrev_b32 v168, 16, v143
    v_and_b32 v169, 0xffff0000, v143
    v_pk_add_f32 v[166:167], v[166:167], v[168:169]
    v_lshlrev_b32 v168, 16, v144
    v_and_b32 v169, 0xffff0000, v144
    v_pk_add_f32 v[160:161], v[160:161], v[168:169]
    v_lshlrev_b32 v168, 16, v145
    v_and_b32 v169, 0xffff0000, v145
    v_pk_add_f32 v[162:163], v[162:163], v[168:169]
    v_lshlrev_b32 v168, 16, v146
    v_and_b32 v169, 0xffff0000, v146
    v_pk_add_f32 v[164:165], v[164:165], v[168:169]
    v_lshlrev_b32 v168, 16, v147
    v_and_b32 v169, 0xffff0000, v147
    v_pk_add_f32 v[166:167], v[166:167], v[168:169]
    v_lshlrev_b32 v168, 16, v148
    v_and_b32 v169, 0xffff0000, v148
    v_pk_add_f32 v[160:161], v[160:161], v[168:169]
    v_lshlrev_b32 v168, 16, v149
    v_and_b32 v169, 0xffff0000, v149
    v_pk_add_f32 v[162:163], v[162:163], v[168:169]
    v_lshlrev_b32 v168, 16, v150
    v_and_b32 v169, 0xffff0000, v150
    v_pk_add_f32 v[164:165], v[164:165], v[168:169]
    v_lshlrev_b32 v168, 16, v151
    v_and_b32 v169, 0xffff0000, v151
    v_pk_add_f32 v[166:167], v[166:167], v[168:169]
    v_lshlrev_b32 v168, 16, v152
    v_and_b32 v169, 0xffff0000, v152
    v_pk_add_f32 v[160:161], v[160:161], v[168:169]
    v_lshlrev_b32 v168, 16, v153
    v_and_b32 v169, 0xffff0000, v153
    v_pk_add_f32 v[162:163], v[162:163], v[168:169]
    v_lshlrev_b32 v168, 16, v154
    v_and_b32 v169, 0xffff0000, v154
    v_pk_add_f32 v[164:165], v[164:165], v[168:169]
    v_lshlrev_b32 v168, 16, v155
    v_and_b32 v169, 0xffff0000, v155
    v_pk_add_f32 v[166:167], v[166:167], v[168:169]
    v_lshlrev_b32 v168, 16, v156
    v_and_b32 v169, 0xffff0000, v156
    v_pk_add_f32 v[160:161], v[160:161], v[168:169]
    v_lshlrev_b32 v168, 16, v157
    v_and_b32 v169, 0xffff0000, v157
    v_pk_add_f32 v[162:163], v[162:163], v[168:169]
    v_lshlrev_b32 v168, 16, v158
    v_and_b32 v169, 0xffff0000, v158
    v_pk_add_f32 v[164:165], v[164:165], v[168:169]
    v_lshlrev_b32 v168, 16, v159
    v_and_b32 v169, 0xffff0000, v159
    v_pk_add_f32 v[166:167], v[166:167], v[168:169]
    s_nop 1
    v_permlane32_swap_b32 v160, v161
    v_permlane32_swap_b32 v162, v163
    v_permlane32_swap_b32 v164, v165
    v_permlane32_swap_b32 v166, v167
    s_nop 0
    v_add_f32 v160, v160, v161
    v_add_f32 v162, v162, v163
    v_add_f32 v164, v164, v165
    v_add_f32 v166, v166, v167
    s_nop 1
    v_permlane16_swap_b32 v160, v162
    v_permlane16_swap_b32 v164, v166
    s_nop 0
    v_add_f32 v160, v160, v162
    v_add_f32 v164, v164, v166
    s_nop 1
    v_add_f32_dpp v160, v160, v160 row_ror:8 row_mask:0xf bank_mask:0xf
    v_add_f32_dpp v164, v164, v164 row_ror:8 row_mask:0xf bank_mask:0xf
    s_lshl_b32 s33, s19, 8
    v_lshlrev_b32 v170, 1, v5
    v_and_b32 v171, 1, v3
    v_lshl_add_u32 v170, v171, 3, v170
    v_lshrrev_b32 v171, 1, v3
    v_lshl_add_u32 v170, v171, 2, v170
    v_add_u32 v170, s33, v170
    ds_write_b32 v170, v160
    ds_write_b32 v170, v164 offset:16
    s_waitcnt lgkmcnt(0)
    s_barrier
    s_cmp_lg_u32 s19, 0
    s_cbranch_scc1 csw_14
    v_lshlrev_b32 v170, 2, v1
    ds_read_b32 v160, v170 offset:0
    ds_read_b32 v161, v170 offset:256
    ds_read_b32 v162, v170 offset:512
    ds_read_b32 v163, v170 offset:768
    ds_read_b32 v164, v170 offset:1024
    ds_read_b32 v165, v170 offset:1280
    ds_read_b32 v166, v170 offset:1536
    ds_read_b32 v167, v170 offset:1792
    s_waitcnt lgkmcnt(0)
    v_add_f32 v160, v160, v161
    v_add_f32 v160, v160, v162
    v_add_f32 v160, v160, v163
    v_add_f32 v160, v160, v164
    v_add_f32 v160, v160, v165
    v_add_f32 v160, v160, v166
    v_add_f32 v160, v160, v167
    s_lshl_b32 s33, s14, 8
    s_add_u32 s33, s33, 11698176
    buffer_store_dword v160, v170, s[28:31], s33 offen sc1
csw_14:
    v_mov_b32 v252, 0
    s_mov_b32 s93, 0
tok_15:
    global_load_dword v253, v252, s[56:57] sc1
    s_add_u32 s93, s93, 1
    s_waitcnt vmcnt(0)
    v_readfirstlane_b32 s84, v253
    s_cmp_ge_u32 s93, 0x4000
    s_cbranch_scc1 tok_16
    s_sub_i32 s85, s82, s84
    s_cmp_lt_i32 s85, 1500
    s_cselect_b32 s85, s84, 0
    s_cmp_lg_u32 s85, 0
    s_cbranch_scc0 tok_15
tok_16:
    s_barrier
    s_cmp_lg_u32 s19, 0
    s_cbranch_scc1 pub_17
    s_lshl_b32 s85, s2, 7
    s_add_u32 s85, s85, 11272192
    v_mov_b32 v252, 0
    v_mov_b32 v253, s84
    s_mov_b64 exec, 1
    buffer_store_dword v253, v252, s[28:31], s85 offen sc1
    s_mov_b64 exec, -1
pub_17:
    s_add_u32 s15, s14, 32
    s_cmp_ge_u32 s15, 35
    s_cbranch_scc1 h_no2
    s_cmp_lt_u32 s15, 7
    s_cselect_b32 s24, s8, s12
    s_cselect_b32 s25, s9, s13
    s_movk_i32 s32, 896
    s_cselect_b32 s32, s32, 3584
    s_cselect_b32 s33, 0, 7
    s_mov_b32 s26, 1605632
    s_cselect_b32 s26, 401408, s26
    s_and_b32 s25, s25, 0xffff
    s_mov_b32 s27, 0x00020000
    s_sub_u32 s33, s15, s33
    s_lshl_b32 s33, s33, 7
    s_mul_i32 s34, s19, 56
    s_mul_i32 s34, s34, s32
    s_add_u32 s33, s33, s34
    v_mul_lo_u32 v130, v7, s32
    v_add_u32 v130, v130, v5
    s_lshl_b32 s32, s32, 3
    buffer_load_dwordx4 v[132:135], v130, s[24:27], s33 offen
    s_add_u32 s33, s33, s32
    buffer_load_dwordx4 v[136:139], v130, s[24:27], s33 offen
    s_add_u32 s33, s33, s32
    buffer_load_dwordx4 v[140:143], v130, s[24:27], s33 offen
    s_add_u32 s33, s33, s32
    buffer_load_dwordx4 v[144:147], v130, s[24:27], s33 offen
    s_add_u32 s33, s33, s32
    buffer_load_dwordx4 v[148:151], v130, s[24:27], s33 offen
    s_add_u32 s33, s33, s32
    buffer_load_dwordx4 v[152:155], v130, s[24:27], s33 offen
    s_add_u32 s33, s33, s32
    buffer_load_dwordx4 v[156:159], v130, s[24:27], s33 offen
    s_add_u32 s33, s33, s32
    s_waitcnt vmcnt(0)
    v_lshlrev_b32 v160, 16, v132
    v_and_b32 v161, 0xffff0000, v132
    v_lshlrev_b32 v162, 16, v133
    v_and_b32 v163, 0xffff0000, v133
    v_lshlrev_b32 v164, 16, v134
    v_and_b32 v165, 0xffff0000, v134
    v_lshlrev_b32 v166, 16, v135
    v_and_b32 v167, 0xffff0000, v135
    v_lshlrev_b32 v168, 16, v136
    v_and_b32 v169, 0xffff0000, v136
    v_pk_add_f32 v[160:161], v[160:161], v[168:169]
    v_lshlrev_b32 v168, 16, v137
    v_and_b32 v169, 0xffff0000, v137
    v_pk_add_f32 v[162:163], v[162:163], v[168:169]
    v_lshlrev_b32 v168, 16, v138
    v_and_b32 v169, 0xffff0000, v138
    v_pk_add_f32 v[164:165], v[164:165], v[168:169]
    v_lshlrev_b32 v168, 16, v139
    v_and_b32 v169, 0xffff0000, v139
    v_pk_add_f32 v[166:167], v[166:167], v[168:169]
    v_lshlrev_b32 v168, 16, v140
    v_and_b32 v169, 0xffff0000, v140
    v_pk_add_f32 v[160:161], v[160:161], v[168:169]
    v_lshlrev_b32 v168, 16, v141
    v_and_b32 v169, 0xffff0000, v141
    v_pk_add_f32 v[162:163], v[162:163], v[168:169]
    v_lshlrev_b32 v168, 16, v142
    v_and_b32 v169, 0xffff0000, v142
    v_pk_add_f32 v[164:165], v[164:165], v[168:169]
    v_lshlrev_b32 v168, 16, v143
    v_and_b32 v169, 0xffff0000, v143
    v_pk_add_f32 v[166:167], v[166:167], v[168:169]
    v_lshlrev_b32 v168, 16, v144
    v_and_b32 v169, 0xffff0000, v144
    v_pk_add_f32 v[160:161], v[160:161], v[168:169]
    v_lshlrev_b32 v168, 16, v145
    v_and_b32 v169, 0xffff0000, v145
    v_pk_add_f32 v[162:163], v[162:163], v[168:169]
    v_lshlrev_b32 v168, 16, v146
    v_and_b32 v169, 0xffff0000, v146
    v_pk_add_f32 v[164:165], v[164:165], v[168:169]
    v_lshlrev_b32 v168, 16, v147
    v_and_b32 v169, 0xffff0000, v147
    v_pk_add_f32 v[166:167], v[166:167], v[168:169]
    v_lshlrev_b32 v168, 16, v148
    v_and_b32 v169, 0xffff0000, v148
    v_pk_add_f32 v[160:161], v[160:161], v[168:169]
    v_lshlrev_b32 v168, 16, v149
    v_and_b32 v169, 0xffff0000, v149
    v_pk_add_f32 v[162:163], v[162:163], v[168:169]
    v_lshlrev_b32 v168, 16, v150
    v_and_b32 v169, 0xffff0000, v150
    v_pk_add_f32 v[164:165], v[164:165], v[168:169]
    v_lshlrev_b32 v168, 16, v151
    v_and_b32 v169, 0xffff0000, v151
    v_pk_add_f32 v[166:167], v[166:167], v[168:169]
    v_lshlrev_b32 v168, 16, v152
    v_and_b32 v169, 0xffff0000, v152
    v_pk_add_f32 v[160:161], v[160:161], v[168:169]
    v_lshlrev_b32 v168, 16, v153
    v_and_b32 v169, 0xffff0000, v153
    v_pk_add_f32 v[162:163], v[162:163], v[168:169]
    v_lshlrev_b32 v168, 16, v154
    v_and_b32 v169, 0xffff0000, v154
    v_pk_add_f32 v[164:165], v[164:165], v[168:169]
    v_lshlrev_b32 v168, 16, v155
    v_and_b32 v169, 0xffff0000, v155
    v_pk_add_f32 v[166:167], v[166:167], v[168:169]
    v_lshlrev_b32 v168, 16, v156
    v_and_b32 v169, 0xffff0000, v156
    v_pk_add_f32 v[160:161], v[160:161], v[168:169]
    v_lshlrev_b32 v168, 16, v157
    v_and_b32 v169, 0xffff0000, v157
    v_pk_add_f32 v[162:163], v[162:163], v[168:169]
    v_lshlrev_b32 v168, 16, v158
    v_and_b32 v169, 0xffff0000, v158
    v_pk_add_f32 v[164:165], v[164:165], v[168:169]
    v_lshlrev_b32 v168, 16, v159
    v_and_b32 v169, 0xffff0000, v159
    v_pk_add_f32 v[166:167], v[166:167], v[168:169]
    s_nop 1
    v_permlane32_swap_b32 v160, v161
    v_permlane32_swap_b32 v162, v163
    v_permlane32_swap_b32 v164, v165
    v_permlane32_swap_b32 v166, v167
    s_nop 0
    v_add_f32 v160, v160, v161
    v_add_f32 v162, v162, v163
    v_add_f32 v164, v164, v165
    v_add_f32 v166, v166, v167
    s_nop 1
    v_permlane16_swap_b32 v160, v162
    v_permlane16_swap_b32 v164, v166
    s_nop 0
    v_add_f32 v160, v160, v162
    v_add_f32 v164, v164, v166
    s_nop 1
    v_add_f32_dpp v160, v160, v160 row_ror:8 row_mask:0xf bank_mask:0xf
    v_add_f32_dpp v164, v164, v164 row_ror:8 row_mask:0xf bank_mask:0xf
    s_lshl_b32 s33, s19, 8
    v_lshlrev_b32 v170, 1, v5
    v_and_b32 v171, 1, v3
    v_lshl_add_u32 v170, v171, 3, v170
    v_lshrrev_b32 v171, 1, v3
    v_lshl_add_u32 v170, v171, 2, v170
    v_add_u32 v170, s33, v170
    ds_write_b32 v170, v160
    ds_write_b32 v170, v164 offset:16
    s_waitcnt lgkmcnt(0)
    s_barrier
    s_cmp_lg_u32 s19, 0
    s_cbranch_scc1 csw_18
    v_lshlrev_b32 v170, 2, v1
    ds_read_b32 v160, v170 offset:0
    ds_read_b32 v161, v170 offset:256
    ds_read_b32 v162, v170 offset:512
    ds_read_b32 v163, v170 offset:768
    ds_read_b32 v164, v170 offset:1024
    ds_read_b32 v165, v170 offset:1280
    ds_read_b32 v166, v170 offset:1536
    ds_read_b32 v167, v170 offset:1792
    s_waitcnt lgkmcnt(0)
    v_add_f32 v160, v160, v161
    v_add_f32 v160, v160, v162
    v_add_f32 v160, v160, v163
    v_add_f32 v160, v160, v164
    v_add_f32 v160, v160, v165
    v_add_f32 v160, v160, v166
    v_add_f32 v160, v160, v167
    s_lshl_b32 s33, s15, 8
    s_add_u32 s33, s33, 11698176
    buffer_store_dword v160, v170, s[28:31], s33 offen sc1
csw_18:
h_no2:
    v_lshlrev_b32 v168, 16, v40
    v_and_b32 v169, 0xffff0000, v40
    v_pk_mul_f32 v[72:73], v[72:73], v[168:169]
    v_lshlrev_b32 v168, 16, v41
    v_and_b32 v169, 0xffff0000, v41
    v_pk_mul_f32 v[74:75], v[74:75], v[168:169]
    v_lshlrev_b32 v168, 16, v42
    v_and_b32 v169, 0xffff0000, v42
    v_pk_mul_f32 v[76:77], v[76:77], v[168:169]
    v_lshlrev_b32 v168, 16, v43
    v_and_b32 v169, 0xffff0000, v43
    v_pk_mul_f32 v[78:79], v[78:79], v[168:169]
    v_lshlrev_b32 v168, 16, v44
    v_and_b32 v169, 0xffff0000, v44
    v_pk_mul_f32 v[80:81], v[80:81], v[168:169]
    v_lshlrev_b32 v168, 16, v45
    v_and_b32 v169, 0xffff0000, v45
    v_pk_mul_f32 v[82:83], v[82:83], v[168:169]
    v_lshlrev_b32 v168, 16, v46
    v_and_b32 v169, 0xffff0000, v46
    v_pk_mul_f32 v[84:85], v[84:85], v[168:169]
    v_lshlrev_b32 v168, 16, v47
    v_and_b32 v169, 0xffff0000, v47
    v_pk_mul_f32 v[86:87], v[86:87], v[168:169]
    v_lshlrev_b32 v168, 16, v48
    v_and_b32 v169, 0xffff0000, v48
    v_pk_mul_f32 v[88:89], v[88:89], v[168:169]
    v_lshlrev_b32 v168, 16, v49
    v_and_b32 v169, 0xffff0000, v49
    v_pk_mul_f32 v[90:91], v[90:91], v[168:169]
    v_lshlrev_b32 v168, 16, v50
    v_and_b32 v169, 0xffff0000, v50
    v_pk_mul_f32 v[92:93], v[92:93], v[168:169]
    v_lshlrev_b32 v168, 16, v51
    v_and_b32 v169, 0xffff0000, v51
    v_pk_mul_f32 v[94:95], v[94:95], v[168:169]
    v_lshlrev_b32 v168, 16, v52
    v_and_b32 v169, 0xffff0000, v52
    v_pk_mul_f32 v[96:97], v[96:97], v[168:169]
    v_lshlrev_b32 v168, 16, v53
    v_and_b32 v169, 0xffff0000, v53
    v_pk_mul_f32 v[98:99], v[98:99], v[168:169]
    v_lshlrev_b32 v168, 16, v54
    v_and_b32 v169, 0xffff0000, v54
    v_pk_mul_f32 v[100:101], v[100:101], v[168:169]
    v_lshlrev_b32 v168, 16, v55
    v_and_b32 v169, 0xffff0000, v55
    v_pk_mul_f32 v[102:103], v[102:103], v[168:169]
    v_lshlrev_b32 v168, 16, v56
    v_and_b32 v169, 0xffff0000, v56
    v_pk_mul_f32 v[104:105], v[104:105], v[168:169]
    v_lshlrev_b32 v168, 16, v57
    v_and_b32 v169, 0xffff0000, v57
    v_pk_mul_f32 v[106:107], v[106:107], v[168:169]
    v_lshlrev_b32 v168, 16, v58
    v_and_b32 v169, 0xffff0000, v58
    v_pk_mul_f32 v[108:109], v[108:109], v[168:169]
    v_lshlrev_b32 v168, 16, v59
    v_and_b32 v169, 0xffff0000, v59
    v_pk_mul_f32 v[110:111], v[110:111], v[168:169]
    v_lshlrev_b32 v168, 16, v60
    v_and_b32 v169, 0xffff0000, v60
    v_pk_mul_f32 v[112:113], v[112:113], v[168:169]
    v_lshlrev_b32 v168, 16, v61
    v_and_b32 v169, 0xffff0000, v61
    v_pk_mul_f32 v[114:115], v[114:115], v[168:169]
    v_lshlrev_b32 v168, 16, v62
    v_and_b32 v169, 0xffff0000, v62
    v_pk_mul_f32 v[116:117], v[116:117], v[168:169]
    v_lshlrev_b32 v168, 16, v63
    v_and_b32 v169, 0xffff0000, v63
    v_pk_mul_f32 v[118:119], v[118:119], v[168:169]
    v_lshlrev_b32 v168, 16, v64
    v_and_b32 v169, 0xffff0000, v64
    v_pk_mul_f32 v[120:121], v[120:121], v[168:169]
    v_lshlrev_b32 v168, 16, v65
    v_and_b32 v169, 0xffff0000, v65
    v_pk_mul_f32 v[122:123], v[122:123], v[168:169]
    v_lshlrev_b32 v168, 16, v66
    v_and_b32 v169, 0xffff0000, v66
    v_pk_mul_f32 v[124:125], v[124:125], v[168:169]
    v_lshlrev_b32 v168, 16, v67
    v_and_b32 v169, 0xffff0000, v67
    v_pk_mul_f32 v[126:127], v[126:127], v[168:169]
    v_cvt_pk_bf16_f32 v72, 0, v72
    v_cvt_pk_bf16_f32 v73, 0, v73
    v_cvt_pk_bf16_f32 v74, 0, v74
    v_cvt_pk_bf16_f32 v75, 0, v75
    v_cvt_pk_bf16_f32 v76, 0, v76
    v_cvt_pk_bf16_f32 v77, 0, v77
    v_cvt_pk_bf16_f32 v78, 0, v78
    v_cvt_pk_bf16_f32 v79, 0, v79
    v_cvt_pk_bf16_f32 v80, 0, v80
    v_cvt_pk_bf16_f32 v81, 0, v81
    v_cvt_pk_bf16_f32 v82, 0, v82
    v_cvt_pk_bf16_f32 v83, 0, v83
    v_cvt_pk_bf16_f32 v84, 0, v84
    v_cvt_pk_bf16_f32 v85, 0, v85
    v_cvt_pk_bf16_f32 v86, 0, v86
    v_cvt_pk_bf16_f32 v87, 0, v87
    v_cvt_pk_bf16_f32 v88, 0, v88
    v_cvt_pk_bf16_f32 v89, 0, v89
    v_cvt_pk_bf16_f32 v90, 0, v90
    v_cvt_pk_bf16_f32 v91, 0, v91
    v_cvt_pk_bf16_f32 v92, 0, v92
    v_cvt_pk_bf16_f32 v93, 0, v93
    v_cvt_pk_bf16_f32 v94, 0, v94
    v_cvt_pk_bf16_f32 v95, 0, v95
    v_cvt_pk_bf16_f32 v96, 0, v96
    v_cvt_pk_bf16_f32 v97, 0, v97
    v_cvt_pk_bf16_f32 v98, 0, v98
    v_cvt_pk_bf16_f32 v99, 0, v99
    v_cvt_pk_bf16_f32 v100, 0, v100
    v_cvt_pk_bf16_f32 v101, 0, v101
    v_cvt_pk_bf16_f32 v102, 0, v102
    v_cvt_pk_bf16_f32 v103, 0, v103
    v_cvt_pk_bf16_f32 v104, 0, v104
    v_cvt_pk_bf16_f32 v105, 0, v105
    v_cvt_pk_bf16_f32 v106, 0, v106
    v_cvt_pk_bf16_f32 v107, 0, v107
    v_cvt_pk_bf16_f32 v108, 0, v108
    v_cvt_pk_bf16_f32 v109, 0, v109
    v_cvt_pk_bf16_f32 v110, 0, v110
    v_cvt_pk_bf16_f32 v111, 0, v111
    v_cvt_pk_bf16_f32 v112, 0, v112
    v_cvt_pk_bf16_f32 v113, 0, v113
    v_cvt_pk_bf16_f32 v114, 0, v114
    v_cvt_pk_bf16_f32 v115, 0, v115
    v_cvt_pk_bf16_f32 v116, 0, v116
    v_cvt_pk_bf16_f32 v117, 0, v117
    v_cvt_pk_bf16_f32 v118, 0, v118
    v_cvt_pk_bf16_f32 v119, 0, v119
    v_cvt_pk_bf16_f32 v120, 0, v120
    v_cvt_pk_bf16_f32 v121, 0, v121
    v_cvt_pk_bf16_f32 v122, 0, v122
    v_cvt_pk_bf16_f32 v123, 0, v123
    v_cvt_pk_bf16_f32 v124, 0, v124
    v_cvt_pk_bf16_f32 v125, 0, v125
    v_cvt_pk_bf16_f32 v126, 0, v126
    v_cvt_pk_bf16_f32 v127, 0, v127
    v_pk_add_f32 v[128:129], v[72:73], v[74:75]
    v_pk_add_f32 v[128:129], v[128:129], v[76:77]
    v_pk_add_f32 v[128:129], v[128:129], v[78:79]
    v_pk_add_f32 v[128:129], v[128:129], v[80:81]
    v_pk_add_f32 v[128:129], v[128:129], v[82:83]
    v_pk_add_f32 v[128:129], v[128:129], v[84:85]
    v_pk_add_f32 v[128:129], v[128:129], v[86:87]
    v_pk_add_f32 v[128:129], v[128:129], v[88:89]
    v_pk_add_f32 v[128:129], v[128:129], v[90:91]
    v_pk_add_f32 v[128:129], v[128:129], v[92:93]
    v_pk_add_f32 v[128:129], v[128:129], v[94:95]
    v_pk_add_f32 v[128:129], v[128:129], v[96:97]
    v_pk_add_f32 v[128:129], v[128:129], v[98:99]
    v_pk_add_f32 v[128:129], v[128:129], v[100:101]
    v_pk_add_f32 v[128:129], v[128:129], v[102:103]
    v_pk_add_f32 v[128:129], v[128:129], v[104:105]
    v_pk_add_f32 v[128:129], v[128:129], v[106:107]
    v_pk_add_f32 v[128:129], v[128:129], v[108:109]
    v_pk_add_f32 v[128:129], v[128:129], v[110:111]
    v_pk_add_f32 v[128:129], v[128:129], v[112:113]
    v_pk_add_f32 v[128:129], v[128:129], v[114:115]
    v_pk_add_f32 v[128:129], v[128:129], v[116:117]
    v_pk_add_f32 v[128:129], v[128:129], v[118:119]
    v_pk_add_f32 v[128:129], v[128:129], v[120:121]
    v_pk_add_f32 v[128:129], v[128:129], v[122:123]
    v_pk_add_f32 v[128:129], v[128:129], v[124:125]
    v_pk_add_f32 v[128:129], v[128:129], v[126:127]
    v_add_f32 v128, v128, v129
    s_nop 1
    v_add_f32_dpp v128, v128, v128 quad_perm:[1,0,3,2] row_mask:0xf bank_mask:0xf
    s_nop 1
    v_add_f32_dpp v128, v128, v128 quad_perm:[2,3,0,1] row_mask:0xf bank_mask:0xf
    s_nop 1
    v_add_f32_dpp v128, v128, v128 row_half_mirror row_mask:0xf bank_mask:0xf
    v_cvt_pk_bf16_f32 v128, 0, v128
    v_mul_f32 v128, 0xbfb8aa3b, v128
    v_exp_f32 v128, v128
    s_nop 0
    v_add_f32 v128, 1.0, v128
    v_rcp_f32 v128, v128
    s_nop 0
    v_cvt_pk_bf16_f32 v128, 0, v128
    v_lshlrev_b32 v170, 2, v4
    s_mov_b32 s33, 11665408
    s_mov_b32 exec_lo, 0x01010101
    s_mov_b32 exec_hi, 0x01010101
    buffer_store_dword v128, v170, s[28:31], s33 offen sc1
    s_mov_b64 exec, -1
    s_waitcnt vmcnt(0)
    s_barrier
    s_cmp_lg_u32 s19, 0
    s_cbranch_scc1 pub_19
    s_lshl_b32 s85, s2, 7
    s_add_u32 s85, s85, 11304960
    v_mov_b32 v252, 0
    v_mov_b32 v253, s84
    s_mov_b64 exec, 1
    buffer_store_dword v253, v252, s[28:31], s85 offen sc1
    s_mov_b64 exec, -1
pub_19:
p1_done:
    s_load_dwordx2 s[4:5], s[0:1], 0
    s_load_dwordx2 s[6:7], s[0:1], 40
    s_load_dwordx2 s[8:9], s[0:1], 48
    s_and_b32 s14, s2, 7
    s_lshr_b32 s15, s2, 3
    s_mul_i32 s16, s15, 9363
    s_lshr_b32 s16, s16, 16
    s_mul_i32 s18, s16, 7
    s_sub_u32 s18, s15, s18
    s_lshl_b32 s17, s14, 2
    s_add_u32 s17, s17, s16
    s_and_b32 s46, s19, 3
    s_lshr_b32 s47, s19, 2
    s_lshr_b32 s16, s15, 4
    s_lshl_b32 s48, s14, 1
    s_add_u32 s48, s48, s16
    s_and_b32 s49, s15, 15
    s_cmp_ge_u32 s2, 224
    s_cbranch_scc1 p2_now2
    v_mov_b32 v5, v241
    s_bitcmp1_b32 s19, 1
    s_cbranch_scc0 sw_20
    v_mov_b32 v5, v242
sw_20:
    s_and_b32 s38, s19, 1
    s_lshl_b32 s38, s38, 6
    v_xor_b32 v5, s38, v5
    s_lshl_b32 s38, s18, 7
    s_mul_i32 s39, s19, 7168
    s_add_u32 s38, s38, s39
    s_lshl_b32 s39, s19, 10
    s_waitcnt lgkmcnt(0)
    s_mov_b32 s20, s4
    s_and_b32 s21, s5, 0xffff
    s_mov_b32 s22, 1835008
    s_mov_b32 s23, 0x00020000
    s_mov_b32 s24, s6
    s_and_b32 s25, s7, 0xffff
    s_mov_b32 s26, 401408
    s_mov_b32 s27, 0x00020000
    s_barrier
    s_mov_b32 m0, s39
    s_add_u32 s39, s39, 8192
    buffer_load_dwordx4 v5, s[24:27], s38 offen lds
    s_add_u32 s38, s38, 57344
    s_mov_b32 m0, s39
    s_add_u32 s39, s39, 8192
    buffer_load_dwordx4 v5, s[24:27], s38 offen lds
    s_add_u32 s38, s38, 57344
    s_mov_b32 m0, s39
    s_add_u32 s39, s39, 8192
    buffer_load_dwordx4 v5, s[24:27], s38 offen lds
    s_add_u32 s38, s38, 57344
    s_mov_b32 m0, s39
    s_add_u32 s39, s39, 8192
    buffer_load_dwordx4 v5, s[24:27], s38 offen lds
    s_add_u32 s38, s38, 57344
    s_mov_b32 m0, s39
    s_add_u32 s39, s39, 8192
    buffer_load_dwordx4 v5, s[24:27], s38 offen lds
    s_add_u32 s38, s38, 57344
    s_mov_b32 m0, s39
    s_add_u32 s39, s39, 8192
    buffer_load_dwordx4 v5, s[24:27], s38 offen lds
    s_add_u32 s38, s38, 57344
    s_mov_b32 m0, s39
    s_add_u32 s39, s39, 8192
    buffer_load_dwordx4 v5, s[24:27], s38 offen lds
    s_add_u32 s38, s38, 57344
    s_waitcnt vmcnt(7)
    s_barrier
    s_cmp_lg_u32 s19, 0
    s_cbranch_scc1 pub_21
    s_lshl_b32 s85, s2, 7
    s_add_u32 s85, s85, 11272192
    v_mov_b32 v252, 0
    v_mov_b32 v253, s84
    s_mov_b64 exec, 1
    buffer_store_dword v253, v252, s[28:31], s85 offen sc1
    s_mov_b64 exec, -1
pub_21:
p2_now2:
    s_mul_i32 s50, s48, 7
    s_lshr_b32 s50, s50, 1
    s_lshl_b32 s51, s49, 3
    s_mul_i32 s52, s19, 3
    s_add_u32 s52, s52, s51
    s_sub_u32 s52, s52, 16
    s_lshl_b32 s54, s50, 8
    s_mul_i32 s55, s19, 3072
    s_add_u32 s55, s55, 114688
    s_lshl_b32 s40, s48, 17
    s_add_u32 s40, s40, 3670016
    s_add_i32 s41, s52, 0
    s_max_i32 s41, s41, 0
    s_mul_i32 s62, s41, 14336
    s_add_u32 s62, s62, s54
    s_add_u32 s62, s62, 1835008
    s_lshl_b32 s41, s41, 10
    s_add_u32 s65, s41, s40
    s_add_i32 s41, s52, 1
    s_max_i32 s41, s41, 0
    s_mul_i32 s63, s41, 14336
    s_add_u32 s63, s63, s54
    s_add_u32 s63, s63, 1835008
    s_lshl_b32 s41, s41, 10
    s_add_u32 s66, s41, s40
    s_add_i32 s41, s52, 2
    s_max_i32 s41, s41, 0
    s_mul_i32 s64, s41, 14336
    s_add_u32 s64, s64, s54
    s_add_u32 s64, s64, 1835008
    s_lshl_b32 s41, s41, 10
    s_add_u32 s67, s41, s40
    s_add_u32 s52, s51, s19
    s_mul_i32 s52, s52, 14336
    s_add_u32 s53, s52, s54
    s_lshl_b32 s32, s17, 2
    s_add_u32 s32, s32, s46
    s_mul_i32 s33, s32, 14336
    s_mul_i32 s34, s47, 7168
    s_add_u32 s34, s34, s33
    s_add_u32 s34, s34, 5767168
    s_add_u32 s35, s34, 4096
    s_cmp_lg_u32 s19, 0
    s_cbranch_scc1 pol_22
    v_mul_u32_u24 v232, 5958, v1
    v_lshrrev_b32 v232, 16, v232
    v_mul_u32_u24 v233, 11, v232
    v_sub_u32 v233, v1, v233
    v_add_u32 v232, s49, v232
    v_subrev_u32 v232, 2, v232
    v_max_i32 v232, 0, v232
    s_lshl_b32 s85, s17, 6
    v_subrev_u32 v234, 33, v1
    v_lshrrev_b32 v235, 2, v234
    v_mul_u32_u24 v235, 67, v235
    v_add_u32 v235, s85, v235
    v_subrev_u32 v235, 2, v235
    v_max_i32 v235, 0, v235
    v_min_i32 v235, 2047, v235
    v_lshrrev_b32 v235, 7, v235
    v_and_b32 v234, 3, v234
    v_add_u32 v234, 10, v234
    v_cmp_lt_u32 vcc, 32, v1
    s_nop 1
    v_cndmask_b32 v232, v232, v235, vcc
    v_cndmask_b32 v233, v233, v234, vcc
    v_lshrrev_b32 v252, 2, v232
    v_lshlrev_b32 v252, 1, v252
    v_cmp_lt_u32 vcc, 6, v233
    s_nop 1
    v_addc_co_u32 v252, vcc, 0, v252, vcc
    v_cmp_lt_u32 vcc, 6, v233
    v_and_b32 v234, 3, v232
    v_mul_u32_u24 v234, 7, v234
    v_add_u32 v234, v234, v233
    v_subrev_u32 v232, 7, v234
    v_cndmask_b32 v234, v234, v232, vcc
    v_lshl_add_u32 v252, v234, 3, v252
    v_lshlrev_b32 v252, 7, v252
    s_cmp_lt_u32 s2, 224
    s_cselect_b32 exec_hi, 0x1ff, 1
    s_mov_b32 s85, 11272192
    s_mov_b32 s93, 0
pol_23:
    buffer_load_dword v253, v252, s[28:31], s85 offen sc1
    s_add_u32 s93, s93, 1
    s_waitcnt vmcnt(0)
    v_cmp_ne_u32 vcc, s84, v253
    s_cmp_lt_u32 s93, 0x20000
    s_cselect_b64 s[94:95], vcc, 0
    s_cmp_lg_u64 s[94:95], 0
    s_cbranch_scc1 pol_23
    s_mov_b64 exec, -1
pol_22:
    s_waitcnt vmcnt(0)
    s_barrier
    s_cmp_ge_u32 s2, 224
    s_cbranch_scc1 p2_noa
    buffer_load_dwordx4 v[32:35], v240, s[28:31], s34 offen offset:0 sc1
    buffer_load_dwordx4 v[36:39], v240, s[28:31], s34 offen offset:1024 sc1
    buffer_load_dwordx4 v[40:43], v240, s[28:31], s34 offen offset:2048 sc1
    buffer_load_dwordx4 v[44:47], v240, s[28:31], s34 offen offset:3072 sc1
    buffer_load_dwordx4 v[48:51], v240, s[28:31], s35 offen offset:0 sc1
    buffer_load_dwordx4 v[52:55], v240, s[28:31], s35 offen offset:1024 sc1
    buffer_load_dwordx4 v[56:59], v240, s[28:31], s35 offen offset:2048 sc1
p2_noa:
    s_add_u32 m0, s55, 0
    s_nop 0
    buffer_load_dwordx4 v240, s[28:31], s62 offen sc1 lds
    s_add_u32 m0, s55, 24576
    s_nop 0
    buffer_load_dwordx4 v240, s[28:31], s65 offen sc1 lds
    s_add_u32 m0, s55, 1024
    s_nop 0
    buffer_load_dwordx4 v240, s[28:31], s63 offen sc1 lds
    s_add_u32 m0, s55, 25600
    s_nop 0
    buffer_load_dwordx4 v240, s[28:31], s66 offen sc1 lds
    s_add_u32 m0, s55, 2048
    s_nop 0
    buffer_load_dwordx4 v240, s[28:31], s64 offen sc1 lds
    s_add_u32 m0, s55, 26624
    s_nop 0
    buffer_load_dwordx4 v240, s[28:31], s67 offen sc1 lds
    buffer_load_dwordx4 v[200:203], v240, s[28:31], s53 offen sc1
    s_cmp_ge_u32 s2, 224
    s_cbranch_scc1 p2_attn
    s_lshl_b32 s40, s32, 4
    v_add_u32 v8, s40, v2
    v_mul_u32_u24 v9, 896, v8
    v_lshrrev_b32 v10, 1, v243
    v_xor_b32 v11, 8, v10
    v_add_u32 v11, v11, v9
    v_add_u32 v9, v10, v9
    s_lshl_b32 s40, s18, 7
    s_lshl_b32 s41, s47, 6
    s_add_u32 s40, s40, s41
    buffer_load_dwordx2 v[112:113], v9, s[20:23], s40 offen
    buffer_load_dwordx2 v[114:115], v11, s[20:23], s40 offen
    s_mul_i32 s41, s47, 28672
    v_add_u32 v16, s41, v236
    v_add_u32 v17, s41, v237
    v_add_u32 v18, s41, v238
    v_add_u32 v19, s41, v239
    ds_read_b64_tr_b16 v[64:65], v16 offset:0
    ds_read_b64_tr_b16 v[66:67], v16 offset:512
    ds_read_b64_tr_b16 v[68:69], v17 offset:0
    ds_read_b64_tr_b16 v[70:71], v17 offset:512
    ds_read_b64_tr_b16 v[72:73], v18 offset:0
    ds_read_b64_tr_b16 v[74:75], v18 offset:512
    ds_read_b64_tr_b16 v[76:77], v19 offset:0
    ds_read_b64_tr_b16 v[78:79], v19 offset:512
    s_xor_b32 s41, s19, 4
    s_lshl_b32 s41, s41, 11
    s_add_u32 s41, s41, 57344
    v_add_u32 v12, s41, v240
    s_lshl_b32 s41, s19, 11
    s_add_u32 s41, s41, 57344
    v_add_u32 v13, s41, v240
    s_waitcnt vmcnt(15) lgkmcnt(0)
    v_mfma_f32_16x16x32_bf16 v[96:99], v[64:67], v[32:35], 0
    ds_read_b64_tr_b16 v[80:81], v16 offset:4096
    ds_read_b64_tr_b16 v[82:83], v16 offset:4608
    ds_read_b64_tr_b16 v[84:85], v17 offset:4096
    ds_read_b64_tr_b16 v[86:87], v17 offset:4608
    v_mfma_f32_16x16x32_bf16 v[100:103], v[68:71], v[32:35], 0
    ds_read_b64_tr_b16 v[88:89], v18 offset:4096
    ds_read_b64_tr_b16 v[90:91], v18 offset:4608
    ds_read_b64_tr_b16 v[92:93], v19 offset:4096
    ds_read_b64_tr_b16 v[94:95], v19 offset:4608
    v_mfma_f32_16x16x32_bf16 v[104:107], v[72:75], v[32:35], 0
    v_mfma_f32_16x16x32_bf16 v[108:111], v[76:79], v[32:35], 0
    s_waitcnt vmcnt(14) lgkmcnt(0)
    v_mfma_f32_16x16x32_bf16 v[96:99], v[80:83], v[36:39], v[96:99]
    ds_read_b64_tr_b16 v[64:65], v16 offset:8192
    ds_read_b64_tr_b16 v[66:67], v16 offset:8704
    ds_read_b64_tr_b16 v[68:69], v17 offset:8192
    ds_read_b64_tr_b16 v[70:71], v17 offset:8704
    v_mfma_f32_16x16x32_bf16 v[100:103], v[84:87], v[36:39], v[100:103]
    ds_read_b64_tr_b16 v[72:73], v18 offset:8192
    ds_read_b64_tr_b16 v[74:75], v18 offset:8704
    ds_read_b64_tr_b16 v[76:77], v19 offset:8192
    ds_read_b64_tr_b16 v[78:79], v19 offset:8704
    v_mfma_f32_16x16x32_bf16 v[104:107], v[88:91], v[36:39], v[104:107]
    v_mfma_f32_16x16x32_bf16 v[108:111], v[92:95], v[36:39], v[108:111]
    s_waitcnt vmcnt(13) lgkmcnt(0)
    v_mfma_f32_16x16x32_bf16 v[96:99], v[64:67], v[40:43], v[96:99]
    ds_read_b64_tr_b16 v[80:81], v16 offset:12288
    ds_read_b64_tr_b16 v[82:83], v16 offset:12800
    ds_read_b64_tr_b16 v[84:85], v17 offset:12288
    ds_read_b64_tr_b16 v[86:87], v17 offset:12800
    v_mfma_f32_16x16x32_bf16 v[100:103], v[68:71], v[40:43], v[100:103]
    ds_read_b64_tr_b16 v[88:89], v18 offset:12288
    ds_read_b64_tr_b16 v[90:91], v18 offset:12800
    ds_read_b64_tr_b16 v[92:93], v19 offset:12288
    ds_read_b64_tr_b16 v[94:95], v19 offset:12800
    v_mfma_f32_16x16x32_bf16 v[104:107], v[72:75], v[40:43], v[104:107]
    v_mfma_f32_16x16x32_bf16 v[108:111], v[76:79], v[40:43], v[108:111]
    s_waitcnt vmcnt(12) lgkmcnt(0)
    v_mfma_f32_16x16x32_bf16 v[96:99], v[80:83], v[44:47], v[96:99]
    ds_read_b64_tr_b16 v[64:65], v16 offset:16384
    ds_read_b64_tr_b16 v[66:67], v16 offset:16896
    ds_read_b64_tr_b16 v[68:69], v17 offset:16384
    ds_read_b64_tr_b16 v[70:71], v17 offset:16896
    v_mfma_f32_16x16x32_bf16 v[100:103], v[84:87], v[44:47], v[100:103]
    ds_read_b64_tr_b16 v[72:73], v18 offset:16384
    ds_read_b64_tr_b16 v[74:75], v18 offset:16896
    ds_read_b64_tr_b16 v[76:77], v19 offset:16384
    ds_read_b64_tr_b16 v[78:79], v19 offset:16896
    v_mfma_f32_16x16x32_bf16 v[104:107], v[88:91], v[44:47], v[104:107]
    v_mfma_f32_16x16x32_bf16 v[108:111], v[92:95], v[44:47], v[108:111]
    s_waitcnt vmcnt(11) lgkmcnt(0)
    v_mfma_f32_16x16x32_bf16 v[96:99], v[64:67], v[48:51], v[96:99]
    ds_read_b64_tr_b16 v[80:81], v16 offset:20480
    ds_read_b64_tr_b16 v[82:83], v16 offset:20992
    ds_read_b64_tr_b16 v[84:85], v17 offset:20480
    ds_read_b64_tr_b16 v[86:87], v17 offset:20992
    v_mfma_f32_16x16x32_bf16 v[100:103], v[68:71], v[48:51], v[100:103]
    ds_read_b64_tr_b16 v[88:89], v18 offset:20480
    ds_read_b64_tr_b16 v[90:91], v18 offset:20992
    ds_read_b64_tr_b16 v[92:93], v19 offset:20480
    ds_read_b64_tr_b16 v[94:95], v19 offset:20992
    v_mfma_f32_16x16x32_bf16 v[104:107], v[72:75], v[48:51], v[104:107]
    v_mfma_f32_16x16x32_bf16 v[108:111], v[76:79], v[48:51], v[108:111]
    s_waitcnt vmcnt(10) lgkmcnt(0)
    v_mfma_f32_16x16x32_bf16 v[96:99], v[80:83], v[52:55], v[96:99]
    ds_read_b64_tr_b16 v[64:65], v16 offset:24576
    ds_read_b64_tr_b16 v[66:67], v16 offset:25088
    ds_read_b64_tr_b16 v[68:69], v17 offset:24576
    ds_read_b64_tr_b16 v[70:71], v17 offset:25088
    v_mfma_f32_16x16x32_bf16 v[100:103], v[84:87], v[52:55], v[100:103]
    ds_read_b64_tr_b16 v[72:73], v18 offset:24576
    ds_read_b64_tr_b16 v[74:75], v18 offset:25088
    ds_read_b64_tr_b16 v[76:77], v19 offset:24576
    ds_read_b64_tr_b16 v[78:79], v19 offset:25088
    v_mfma_f32_16x16x32_bf16 v[104:107], v[88:91], v[52:55], v[104:107]
    v_mfma_f32_16x16x32_bf16 v[108:111], v[92:95], v[52:55], v[108:111]
    s_waitcnt vmcnt(9) lgkmcnt(0)
    v_mfma_f32_16x16x32_bf16 v[96:99], v[64:67], v[56:59], v[96:99]
    v_mfma_f32_16x16x32_bf16 v[100:103], v[68:71], v[56:59], v[100:103]
    v_mfma_f32_16x16x32_bf16 v[104:107], v[72:75], v[56:59], v[104:107]
    v_mfma_f32_16x16x32_bf16 v[108:111], v[76:79], v[56:59], v[108:111]
    s_waitcnt vmcnt(0)
    v_lshlrev_b32 v32, 16, v112
    v_and_b32 v33, 0xffff0000, v112
    v_lshlrev_b32 v34, 16, v113
    v_and_b32 v35, 0xffff0000, v113
    v_lshlrev_b32 v36, 16, v114
    v_and_b32 v37, 0xffff0000, v114
    v_lshlrev_b32 v38, 16, v115
    v_and_b32 v39, 0xffff0000, v115
    s_cmp_eq_u32 s47, 0
    s_cbranch_scc1 p2_x0
    v_swap_b32 v96, v104
    v_swap_b32 v97, v105
    v_swap_b32 v98, v106
    v_swap_b32 v99, v107
    v_swap_b32 v100, v108
    v_swap_b32 v101, v109
    v_swap_b32 v102, v110
    v_swap_b32 v103, v111
p2_x0:
    ds_write_b128 v12, v[104:107] offset:0
    ds_write_b128 v12, v[108:111] offset:1024
    s_lshl_b32 s40, s18, 11
    s_add_u32 s40, s40, s33
    s_lshl_b32 s41, s47, 10
    s_add_u32 s40, s40, s41
    s_add_u32 s40, s40, 7602176
    s_waitcnt lgkmcnt(0)
    s_barrier
    ds_read_b128 v[104:107], v13 offset:0
    ds_read_b128 v[108:111], v13 offset:1024
    s_waitcnt lgkmcnt(0)
    v_add_f32 v96, v96, v104
    v_add_f32 v97, v97, v105
    v_add_f32 v98, v98, v106
    v_add_f32 v99, v99, v107
    v_add_f32 v100, v100, v108
    v_add_f32 v101, v101, v109
    v_add_f32 v102, v102, v110
    v_add_f32 v103, v103, v111
    v_add_f32 v96, v96, v32
    v_add_f32 v97, v97, v33
    v_add_f32 v98, v98, v34
    v_add_f32 v99, v99, v35
    v_add_f32 v100, v100, v36
    v_add_f32 v101, v101, v37
    v_add_f32 v102, v102, v38
    v_add_f32 v103, v103, v39
    v_cvt_pk_bf16_f32 v248, v96, v97
    v_cvt_pk_bf16_f32 v249, v98, v99
    v_cvt_pk_bf16_f32 v250, v100, v101
    v_cvt_pk_bf16_f32 v251, v102, v103
    buffer_store_dwordx4 v[248:251], v240, s[28:31], s40 offen sc1
    v_cvt_pk_bf16_f32 v96, 0, v96
    v_cvt_pk_bf16_f32 v97, 0, v97
    v_cvt_pk_bf16_f32 v98, 0, v98
    v_cvt_pk_bf16_f32 v99, 0, v99
    v_cvt_pk_bf16_f32 v100, 0, v100
    v_cvt_pk_bf16_f32 v101, 0, v101
    v_cvt_pk_bf16_f32 v102, 0, v102
    v_cvt_pk_bf16_f32 v103, 0, v103
    v_add_f32 v12, v96, v97
    v_add_f32 v12, v12, v98
    v_add_f32 v12, v12, v99
    v_add_f32 v12, v12, v100
    v_add_f32 v12, v12, v101
    v_add_f32 v12, v12, v102
    v_add_f32 v12, v12, v103
    v_mov_b32 v14, v12
    v_mov_b32 v15, v12
    s_nop 1
    v_permlane16_swap_b32 v14, v15
    s_nop 1
    v_add_f32 v12, v14, v15
    v_mov_b32 v14, v12
    v_mov_b32 v15, v12
    s_nop 1
    v_permlane32_swap_b32 v14, v15
    s_nop 1
    v_add_f32 v12, v14, v15
    v_mul_f32 v14, 0x3d000000, v12
    v_sub_f32 v96, v96, v14
    v_sub_f32 v97, v97, v14
    v_sub_f32 v98, v98, v14
    v_sub_f32 v99, v99, v14
    v_sub_f32 v100, v100, v14
    v_sub_f32 v101, v101, v14
    v_sub_f32 v102, v102, v14
    v_sub_f32 v103, v103, v14
    v_mul_f32 v13, v96, v96
    v_fmac_f32 v13, v97, v97
    v_fmac_f32 v13, v98, v98
    v_fmac_f32 v13, v99, v99
    v_fmac_f32 v13, v100, v100
    v_fmac_f32 v13, v101, v101
    v_fmac_f32 v13, v102, v102
    v_fmac_f32 v13, v103, v103
    v_mov_b32 v14, v13
    v_mov_b32 v15, v13
    s_nop 1
    v_permlane16_swap_b32 v14, v15
    s_nop 1
    v_add_f32 v13, v14, v15
    v_mov_b32 v14, v13
    v_mov_b32 v15, v13
    s_nop 1
    v_permlane32_swap_b32 v14, v15
    s_nop 1
    v_add_f32 v13, v14, v15
    v_lshlrev_b32 v8, 7, v8
    s_lshl_b32 s40, s18, 4
    s_lshl_b32 s41, s47, 3
    s_add_u32 s40, s40, s41
    s_add_u32 s40, s40, 11403264
    s_mov_b64 exec, 0xffff
    buffer_store_dwordx2 v[12:13], v8, s[28:31], s40 offen sc1
    s_mov_b64 exec, -1
    s_branch p2_attn2
p2_attn:
    s_waitcnt vmcnt(0)
    s_barrier
p2_attn2:
    s_load_dwordx4 s[4:7], s[0:1], 40
    s_load_dwordx2 s[8:9], s[0:1], 56
    s_load_dwordx2 s[10:11], s[0:1], 16
    s_lshl_b32 s61, s19, 10
    s_add_u32 s61, s61, 114688
    v_add_u32 v4, s61, v240
    ds_read_b128 v[20:23], v4 offset:0
    ds_read_b128 v[24:27], v4 offset:1024
    ds_read_b128 v[28:31], v4 offset:2048
    v_mov_b32 v141, 0xf149f2ca
    v_lshl_add_u32 v140, v3, 2, 0
    v_cmp_gt_u32 vcc, v140, v2
    v_mov_b32 v8, v200
    s_nop 0
    v_cndmask_b32 v12, v141, 0, vcc
    v_cndmask_b32 v16, 0, v141, vcc
    v_lshl_add_u32 v140, v3, 2, 1
    v_cmp_gt_u32 vcc, v140, v2
    v_mov_b32 v9, v201
    s_nop 0
    v_cndmask_b32 v13, v141, 0, vcc
    v_cndmask_b32 v17, 0, v141, vcc
    v_lshl_add_u32 v140, v3, 2, 2
    v_cmp_gt_u32 vcc, v140, v2
    v_mov_b32 v10, v202
    s_nop 0
    v_cndmask_b32 v14, v141, 0, vcc
    v_cndmask_b32 v18, 0, v141, vcc
    v_lshl_add_u32 v140, v3, 2, 3
    v_cmp_gt_u32 vcc, v140, v2
    v_mov_b32 v11, v203
    s_nop 0
    v_cndmask_b32 v15, v141, 0, vcc
    v_cndmask_b32 v19, 0, v141, vcc
    s_lshr_b32 s53, s48, 1
    s_mul_i32 s53, s53, 7
    s_add_u32 s53, s53, 3
    s_lshr_b32 s53, s53, 1
    s_xor_b32 s53, s53, s48
    s_bitcmp1_b32 s48, 0
    s_cselect_b32 exec_lo, 0xffff, 0
    s_cselect_b32 exec_hi, 0, 0xffff0000
    s_bitcmp1_b32 s53, 0
    s_cbranch_scc1 p2_q01
    v_mov_b32 v10, 0
    v_mov_b32 v11, 0
    s_branch p2_qz
p2_q01:
    v_mov_b32 v8, 0
    v_mov_b32 v9, 0
p2_qz:
    s_mov_b64 exec, -1
    s_add_u32 s61, s51, s19
    s_sub_i32 s61, 16, s61
    s_cmp_gt_i32 s61, 0
    s_cbranch_scc1 p2_qkslow
    ds_read_b128 v[32:35], v4 offset:3072
    s_waitcnt lgkmcnt(3)
    v_mfma_f32_16x16x32_bf16 v[36:39], v[20:23], v[8:11], v[12:15]
    ds_read_b128 v[20:23], v4 offset:4096
    s_waitcnt lgkmcnt(3)
    v_mfma_f32_16x16x32_bf16 v[40:43], v[24:27], v[8:11], 0
    ds_read_b128 v[24:27], v4 offset:5120
    s_waitcnt lgkmcnt(3)
    v_mfma_f32_16x16x32_bf16 v[44:47], v[28:31], v[8:11], 0
    ds_read_b128 v[28:31], v4 offset:6144
    s_waitcnt lgkmcnt(3)
    v_mfma_f32_16x16x32_bf16 v[48:51], v[32:35], v[8:11], 0
    ds_read_b128 v[32:35], v4 offset:7168
    s_waitcnt lgkmcnt(3)
    v_mfma_f32_16x16x32_bf16 v[52:55], v[20:23], v[8:11], 0
    ds_read_b128 v[20:23], v4 offset:8192
    s_waitcnt lgkmcnt(3)
    v_mfma_f32_16x16x32_bf16 v[56:59], v[24:27], v[8:11], 0
    ds_read_b128 v[24:27], v4 offset:9216
    s_waitcnt lgkmcnt(3)
    v_mfma_f32_16x16x32_bf16 v[60:63], v[28:31], v[8:11], 0
    ds_read_b128 v[28:31], v4 offset:10240
    s_waitcnt lgkmcnt(3)
    v_mfma_f32_16x16x32_bf16 v[64:67], v[32:35], v[8:11], 0
    ds_read_b128 v[32:35], v4 offset:11264
    s_waitcnt lgkmcnt(3)
    v_mfma_f32_16x16x32_bf16 v[68:71], v[20:23], v[8:11], 0
    ds_read_b128 v[20:23], v4 offset:12288
    s_waitcnt lgkmcnt(3)
    v_mfma_f32_16x16x32_bf16 v[72:75], v[24:27], v[8:11], 0
    ds_read_b128 v[24:27], v4 offset:13312
    s_waitcnt lgkmcnt(3)
    v_mfma_f32_16x16x32_bf16 v[76:79], v[28:31], v[8:11], 0
    ds_read_b128 v[28:31], v4 offset:14336
    s_waitcnt lgkmcnt(3)
    v_mfma_f32_16x16x32_bf16 v[80:83], v[32:35], v[8:11], 0
    ds_read_b128 v[32:35], v4 offset:15360
    s_waitcnt lgkmcnt(3)
    v_mfma_f32_16x16x32_bf16 v[84:87], v[20:23], v[8:11], 0
    ds_read_b128 v[20:23], v4 offset:16384
    s_waitcnt lgkmcnt(3)
    v_mfma_f32_16x16x32_bf16 v[88:91], v[24:27], v[8:11], 0
    s_waitcnt lgkmcnt(2)
    v_mfma_f32_16x16x32_bf16 v[92:95], v[28:31], v[8:11], 0
    s_waitcnt lgkmcnt(1)
    v_mfma_f32_16x16x32_bf16 v[96:99], v[32:35], v[8:11], 0
    s_waitcnt lgkmcnt(0)
    v_mfma_f32_16x16x32_bf16 v[100:103], v[20:23], v[8:11], v[16:19]
    s_branch p2_qkdone
p2_qkslow:
    ds_read_b128 v[32:35], v4 offset:3072
    s_waitcnt lgkmcnt(3)
    s_cmp_gt_i32 s61, 0
    s_cbranch_scc1 k2i_24
    v_mfma_f32_16x16x32_bf16 v[36:39], v[20:23], v[8:11], v[12:15]
    s_branch k2j_25
k2i_24:
    v_mov_b32 v36, 0xf149f2ca
    v_mov_b32 v37, 0xf149f2ca
    v_mov_b32 v38, 0xf149f2ca
    v_mov_b32 v39, 0xf149f2ca
k2j_25:
    ds_read_b128 v[20:23], v4 offset:4096
    s_waitcnt lgkmcnt(3)
    s_cmp_gt_i32 s61, 1
    s_cbranch_scc1 k2i_26
    v_mfma_f32_16x16x32_bf16 v[40:43], v[24:27], v[8:11], 0
    s_branch k2j_27
k2i_26:
    v_mov_b32 v40, 0xf149f2ca
    v_mov_b32 v41, 0xf149f2ca
    v_mov_b32 v42, 0xf149f2ca
    v_mov_b32 v43, 0xf149f2ca
k2j_27:
    ds_read_b128 v[24:27], v4 offset:5120
    s_waitcnt lgkmcnt(3)
    s_cmp_gt_i32 s61, 2
    s_cbranch_scc1 k2i_28
    v_mfma_f32_16x16x32_bf16 v[44:47], v[28:31], v[8:11], 0
    s_branch k2j_29
k2i_28:
    v_mov_b32 v44, 0xf149f2ca
    v_mov_b32 v45, 0xf149f2ca
    v_mov_b32 v46, 0xf149f2ca
    v_mov_b32 v47, 0xf149f2ca
k2j_29:
    ds_read_b128 v[28:31], v4 offset:6144
    s_waitcnt lgkmcnt(3)
    s_cmp_gt_i32 s61, 3
    s_cbranch_scc1 k2i_30
    v_mfma_f32_16x16x32_bf16 v[48:51], v[32:35], v[8:11], 0
    s_branch k2j_31
k2i_30:
    v_mov_b32 v48, 0xf149f2ca
    v_mov_b32 v49, 0xf149f2ca
    v_mov_b32 v50, 0xf149f2ca
    v_mov_b32 v51, 0xf149f2ca
k2j_31:
    ds_read_b128 v[32:35], v4 offset:7168
    s_waitcnt lgkmcnt(3)
    s_cmp_gt_i32 s61, 4
    s_cbranch_scc1 k2i_32
    v_mfma_f32_16x16x32_bf16 v[52:55], v[20:23], v[8:11], 0
    s_branch k2j_33
k2i_32:
    v_mov_b32 v52, 0xf149f2ca
    v_mov_b32 v53, 0xf149f2ca
    v_mov_b32 v54, 0xf149f2ca
    v_mov_b32 v55, 0xf149f2ca
k2j_33:
    ds_read_b128 v[20:23], v4 offset:8192
    s_waitcnt lgkmcnt(3)
    s_cmp_gt_i32 s61, 5
    s_cbranch_scc1 k2i_34
    v_mfma_f32_16x16x32_bf16 v[56:59], v[24:27], v[8:11], 0
    s_branch k2j_35
k2i_34:
    v_mov_b32 v56, 0xf149f2ca
    v_mov_b32 v57, 0xf149f2ca
    v_mov_b32 v58, 0xf149f2ca
    v_mov_b32 v59, 0xf149f2ca
k2j_35:
    ds_read_b128 v[24:27], v4 offset:9216
    s_waitcnt lgkmcnt(3)
    s_cmp_gt_i32 s61, 6
    s_cbranch_scc1 k2i_36
    v_mfma_f32_16x16x32_bf16 v[60:63], v[28:31], v[8:11], 0
    s_branch k2j_37
k2i_36:
    v_mov_b32 v60, 0xf149f2ca
    v_mov_b32 v61, 0xf149f2ca
    v_mov_b32 v62, 0xf149f2ca
    v_mov_b32 v63, 0xf149f2ca
k2j_37:
    ds_read_b128 v[28:31], v4 offset:10240
    s_waitcnt lgkmcnt(3)
    s_cmp_gt_i32 s61, 7
    s_cbranch_scc1 k2i_38
    v_mfma_f32_16x16x32_bf16 v[64:67], v[32:35], v[8:11], 0
    s_branch k2j_39
k2i_38:
    v_mov_b32 v64, 0xf149f2ca
    v_mov_b32 v65, 0xf149f2ca
    v_mov_b32 v66, 0xf149f2ca
    v_mov_b32 v67, 0xf149f2ca
k2j_39:
    ds_read_b128 v[32:35], v4 offset:11264
    s_waitcnt lgkmcnt(3)
    s_cmp_gt_i32 s61, 8
    s_cbranch_scc1 k2i_40
    v_mfma_f32_16x16x32_bf16 v[68:71], v[20:23], v[8:11], 0
    s_branch k2j_41
k2i_40:
    v_mov_b32 v68, 0xf149f2ca
    v_mov_b32 v69, 0xf149f2ca
    v_mov_b32 v70, 0xf149f2ca
    v_mov_b32 v71, 0xf149f2ca
k2j_41:
    ds_read_b128 v[20:23], v4 offset:12288
    s_waitcnt lgkmcnt(3)
    s_cmp_gt_i32 s61, 9
    s_cbranch_scc1 k2i_42
    v_mfma_f32_16x16x32_bf16 v[72:75], v[24:27], v[8:11], 0
    s_branch k2j_43
k2i_42:
    v_mov_b32 v72, 0xf149f2ca
    v_mov_b32 v73, 0xf149f2ca
    v_mov_b32 v74, 0xf149f2ca
    v_mov_b32 v75, 0xf149f2ca
k2j_43:
    ds_read_b128 v[24:27], v4 offset:13312
    s_waitcnt lgkmcnt(3)
    s_cmp_gt_i32 s61, 10
    s_cbranch_scc1 k2i_44
    v_mfma_f32_16x16x32_bf16 v[76:79], v[28:31], v[8:11], 0
    s_branch k2j_45
k2i_44:
    v_mov_b32 v76, 0xf149f2ca
    v_mov_b32 v77, 0xf149f2ca
    v_mov_b32 v78, 0xf149f2ca
    v_mov_b32 v79, 0xf149f2ca
k2j_45:
    ds_read_b128 v[28:31], v4 offset:14336
    s_waitcnt lgkmcnt(3)
    s_cmp_gt_i32 s61, 11
    s_cbranch_scc1 k2i_46
    v_mfma_f32_16x16x32_bf16 v[80:83], v[32:35], v[8:11], 0
    s_branch k2j_47
k2i_46:
    v_mov_b32 v80, 0xf149f2ca
    v_mov_b32 v81, 0xf149f2ca
    v_mov_b32 v82, 0xf149f2ca
    v_mov_b32 v83, 0xf149f2ca
k2j_47:
    ds_read_b128 v[32:35], v4 offset:15360
    s_waitcnt lgkmcnt(3)
    s_cmp_gt_i32 s61, 12
    s_cbranch_scc1 k2i_48
    v_mfma_f32_16x16x32_bf16 v[84:87], v[20:23], v[8:11], 0
    s_branch k2j_49
k2i_48:
    v_mov_b32 v84, 0xf149f2ca
    v_mov_b32 v85, 0xf149f2ca
    v_mov_b32 v86, 0xf149f2ca
    v_mov_b32 v87, 0xf149f2ca
k2j_49:
    ds_read_b128 v[20:23], v4 offset:16384
    s_waitcnt lgkmcnt(3)
    s_cmp_gt_i32 s61, 13
    s_cbranch_scc1 k2i_50
    v_mfma_f32_16x16x32_bf16 v[88:91], v[24:27], v[8:11], 0
    s_branch k2j_51
k2i_50:
    v_mov_b32 v88, 0xf149f2ca
    v_mov_b32 v89, 0xf149f2ca
    v_mov_b32 v90, 0xf149f2ca
    v_mov_b32 v91, 0xf149f2ca
k2j_51:
    s_waitcnt lgkmcnt(2)
    s_cmp_gt_i32 s61, 14
    s_cbranch_scc1 k2i_52
    v_mfma_f32_16x16x32_bf16 v[92:95], v[28:31], v[8:11], 0
    s_branch k2j_53
k2i_52:
    v_mov_b32 v92, 0xf149f2ca
    v_mov_b32 v93, 0xf149f2ca
    v_mov_b32 v94, 0xf149f2ca
    v_mov_b32 v95, 0xf149f2ca
k2j_53:
    s_waitcnt lgkmcnt(1)
    s_cmp_gt_i32 s61, 15
    s_cbranch_scc1 k2i_54
    v_mfma_f32_16x16x32_bf16 v[96:99], v[32:35], v[8:11], 0
    s_branch k2j_55
k2i_54:
    v_mov_b32 v96, 0xf149f2ca
    v_mov_b32 v97, 0xf149f2ca
    v_mov_b32 v98, 0xf149f2ca
    v_mov_b32 v99, 0xf149f2ca
k2j_55:
    s_waitcnt lgkmcnt(0)
    v_mfma_f32_16x16x32_bf16 v[100:103], v[20:23], v[8:11], v[16:19]
p2_qkdone:
    s_lshr_b32 s61, s19, 1
    s_lshl_b32 s61, s61, 11
    s_add_u32 s61, s61, 139264
    v_add_u32 v5, s61, v240
    ds_read_b128 v[20:23], v5 offset:0
    ds_read_b128 v[24:27], v5 offset:1024
    v_max3_f32 v140, v36, v37, v38
    v_max3_f32 v141, v39, v40, v41
    v_max3_f32 v140, v140, v42, v43
    v_max3_f32 v141, v141, v44, v45
    v_max3_f32 v140, v140, v46, v47
    v_max3_f32 v141, v141, v48, v49
    v_max3_f32 v140, v140, v50, v51
    v_max3_f32 v141, v141, v52, v53
    v_max3_f32 v140, v140, v54, v55
    v_max3_f32 v141, v141, v56, v57
    v_max3_f32 v140, v140, v58, v59
    v_max3_f32 v141, v141, v60, v61
    v_max3_f32 v140, v140, v62, v63
    v_max3_f32 v141, v141, v64, v65
    v_max3_f32 v140, v140, v66, v67
    v_max3_f32 v141, v141, v68, v69
    v_max3_f32 v140, v140, v70, v71
    v_max3_f32 v141, v141, v72, v73
    v_max3_f32 v140, v140, v74, v75
    v_max3_f32 v141, v141, v76, v77
    v_max3_f32 v140, v140, v78, v79
    v_max3_f32 v141, v141, v80, v81
    v_max3_f32 v140, v140, v82, v83
    v_max3_f32 v141, v141, v84, v85
    v_max3_f32 v140, v140, v86, v87
    v_max3_f32 v141, v141, v88, v89
    v_max3_f32 v140, v140, v90, v91
    v_max3_f32 v141, v141, v92, v93
    v_max3_f32 v140, v140, v94, v95
    v_max3_f32 v141, v141, v96, v97
    v_max3_f32 v140, v140, v98, v99
    v_max3_f32 v141, v141, v100, v101
    v_max3_f32 v140, v140, v102, v103
    v_max_f32 v140, v140, v141
    v_mov_b32 v141, v140
    v_mov_b32 v142, v140
    s_nop 1
    v_permlane16_swap_b32 v141, v142
    s_nop 1
    v_max_f32 v140, v141, v142
    v_mov_b32 v141, v140
    v_mov_b32 v142, v140
    s_nop 1
    v_permlane32_swap_b32 v141, v142
    s_nop 1
    v_max_f32 v140, v141, v142
    v_mov_b32 v157, 0x3e8b97f6
    v_mul_f32 v158, 0xbe8b97f6, v140
    s_mul_i32 s60, s48, 7
    v_add_u32 v6, s60, v3
    v_and_b32 v140, 1, v6
    v_lshrrev_b32 v6, 1, v6
    v_lshlrev_b32 v6, 8, v6
    v_lshl_add_u32 v6, v140, 3, v6
    v_lshl_add_u32 v6, v2, 4, v6
    s_add_u32 s60, s52, 9437184
    s_and_b32 s14, s2, 7
    s_lshr_b32 s15, s2, 3
    s_mul_i32 s16, s15, 9363
    s_lshr_b32 s16, s16, 16
    s_mul_i32 s18, s16, 7
    s_sub_u32 s18, s15, s18
    s_lshr_b32 s17, s14, 1
    s_lshl_b32 s17, s17, 2
    s_add_u32 s17, s17, s16
    s_and_b32 s16, s14, 1
    s_mul_i32 s16, s16, 7
    s_add_u32 s18, s18, s16
    s_and_b32 s40, s19, 3
    s_lshr_b32 s41, s19, 2
    s_lshl_b32 s36, s19, 11
    s_lshl_b32 s37, s41, 13
    s_lshl_b32 s42, s40, 10
    s_add_u32 s37, s37, s42
    s_add_u32 s37, s37, 16384
    s_lshl_b32 s33, s18, 1
    s_add_u32 s33, s33, s41
    s_and_b32 s43, s40, 1
    s_lshl_b32 s43, s43, 2
    s_mul_i32 s34, s40, 28672
    s_lshl_b32 s35, s33, 7
    s_add_u32 s34, s34, s35
    s_mov_b32 s38, 114688
    s_and_b32 s42, s40, 2
    s_lshl_b32 s42, s42, 1
    v_lshrrev_b32 v205, 3, v1
    v_and_b32 v206, 2, v205
    v_add_u32 v206, s43, v206
    v_xor_b32 v206, v206, v1
    v_and_b32 v206, 7, v206
    v_xor_b32 v205, s42, v205
    v_mul_u32_u24 v204, 3584, v205
    v_lshl_add_u32 v204, v206, 4, v204
    v_cmp_lt_u32 vcc, 6, v1
    s_lshl_b32 s85, s17, 1
    v_mov_b32 v232, s85
    v_addc_co_u32 v232, vcc, 0, v232, vcc
    v_cmp_lt_u32 vcc, 6, v1
    v_subrev_u32 v233, 7, v1
    s_nop 0
    v_cndmask_b32 v233, v1, v233, vcc
    v_and_b32 v234, 3, v232
    v_mul_u32_u24 v234, 7, v234
    v_add_u32 v234, v234, v233
    v_lshrrev_b32 v232, 2, v232
    v_lshl_add_u32 v232, v234, 3, v232
    s_add_u32 s85, s33, 7
    s_and_b32 s85, s85, 31
    s_add_u32 s85, s85, 224
    v_writelane_b32 v232, s85, 14
    v_lshlrev_b32 v232, 7, v232
    v_add_u32 v232, 32768, v232
    s_lshl_b32 s35, s17, 3
    s_add_u32 s35, s35, s19
    s_mul_i32 s35, s35, 14336
    s_add_u32 s35, s35, 7602176
    v_mov_b32 v4, v240
    s_mov_b32 s20, s58
    s_and_b32 s21, s59, 0xffff
    s_mov_b32 s22, 33554432
    s_mov_b32 s23, 0x00020000
    s_mov_b32 s98, 0
    s_mov_b32 s24, s6
    s_and_b32 s25, s7, 0xffff
    s_mov_b32 s26, 1605632
    s_mov_b32 s27, 0x00020000
    s_waitcnt vmcnt(0)
    s_barrier
    s_cmp_ge_u32 s2, 224
    s_cbranch_scc1 p2_now3
    s_cmp_lg_u32 s19, 0
    s_cbranch_scc1 pub_56
    s_lshl_b32 s85, s2, 7
    s_add_u32 s85, s85, 11304960
    v_mov_b32 v252, 0
    v_mov_b32 v253, s84
    s_mov_b64 exec, 1
    buffer_store_dword v253, v252, s[28:31], s85 offen sc1
    s_mov_b64 exec, -1
pub_56:
    s_add_u32 m0, s37, 0
    s_nop 0
    buffer_load_dwordx4 v204, s[24:27], s34 offen lds
    s_add_u32 s34, s34, s38
    s_add_u32 m0, s37, 4096
    s_nop 0
    buffer_load_dwordx4 v204, s[24:27], s34 offen lds
    s_add_u32 s34, s34, s38
    s_add_u32 m0, s37, 32768
    s_nop 0
    buffer_load_dwordx4 v204, s[24:27], s34 offen lds
    s_add_u32 s34, s34, s38
    s_add_u32 m0, s37, 36864
    s_nop 0
    buffer_load_dwordx4 v204, s[24:27], s34 offen lds
    s_add_u32 s34, s34, s38
    s_add_u32 m0, s37, 65536
    s_nop 0
    buffer_load_dwordx4 v204, s[24:27], s34 offen lds
    s_add_u32 s34, s34, s38
    s_add_u32 m0, s37, 69632
    s_nop 0
    buffer_load_dwordx4 v204, s[24:27], s34 offen lds
    s_add_u32 s34, s34, s38
p2_now3:
    s_bitcmp1_b32 s19, 0
    s_cbranch_scc1 p2_odd
    v_mov_b32 v138, 0
    v_mov_b32 v139, 0
    v_fma_f32 v36, v36, v157, v158
    v_fma_f32 v37, v37, v157, v158
    v_fma_f32 v38, v38, v157, v158
    v_fma_f32 v39, v39, v157, v158
    v_fma_f32 v40, v40, v157, v158
    v_fma_f32 v41, v41, v157, v158
    v_fma_f32 v42, v42, v157, v158
    v_fma_f32 v43, v43, v157, v158
    v_exp_f32 v36, v36
    v_exp_f32 v37, v37
    v_exp_f32 v38, v38
    v_exp_f32 v39, v39
    v_exp_f32 v40, v40
    v_exp_f32 v41, v41
    v_exp_f32 v42, v42
    v_exp_f32 v43, v43
    ds_read_b128 v[28:31], v5 offset:2048
    ds_read_b128 v[32:35], v5 offset:3072
    v_cvt_pk_bf16_f32 v104, v36, v37
    v_cvt_pk_bf16_f32 v105, v38, v39
    v_cvt_pk_bf16_f32 v106, v40, v41
    v_cvt_pk_bf16_f32 v107, v42, v43
    s_waitcnt lgkmcnt(2)
    s_nop 0
    v_mfma_f32_16x16x32_bf16 v[160:163], v[20:23], v[104:107], 0
    v_mfma_f32_16x16x32_bf16 v[164:167], v[24:27], v[104:107], 0
    v_fma_f32 v44, v44, v157, v158
    v_fma_f32 v45, v45, v157, v158
    v_fma_f32 v46, v46, v157, v158
    v_fma_f32 v47, v47, v157, v158
    v_fma_f32 v48, v48, v157, v158
    v_fma_f32 v49, v49, v157, v158
    v_fma_f32 v50, v50, v157, v158
    v_fma_f32 v51, v51, v157, v158
    v_exp_f32 v44, v44
    v_exp_f32 v45, v45
    v_exp_f32 v46, v46
    v_exp_f32 v47, v47
    v_exp_f32 v48, v48
    v_exp_f32 v49, v49
    v_exp_f32 v50, v50
    v_exp_f32 v51, v51
    ds_read_b128 v[20:23], v5 offset:4096
    ds_read_b128 v[24:27], v5 offset:5120
    v_cvt_pk_bf16_f32 v108, v44, v45
    v_cvt_pk_bf16_f32 v109, v46, v47
    v_cvt_pk_bf16_f32 v110, v48, v49
    v_cvt_pk_bf16_f32 v111, v50, v51
    s_waitcnt lgkmcnt(2)
    s_nop 0
    v_mfma_f32_16x16x32_bf16 v[160:163], v[28:31], v[108:111], v[160:163]
    v_mfma_f32_16x16x32_bf16 v[164:167], v[32:35], v[108:111], v[164:167]
    v_fma_f32 v52, v52, v157, v158
    v_fma_f32 v53, v53, v157, v158
    v_fma_f32 v54, v54, v157, v158
    v_fma_f32 v55, v55, v157, v158
    v_fma_f32 v56, v56, v157, v158
    v_fma_f32 v57, v57, v157, v158
    v_fma_f32 v58, v58, v157, v158
    v_fma_f32 v59, v59, v157, v158
    v_exp_f32 v52, v52
    v_exp_f32 v53, v53
    v_exp_f32 v54, v54
    v_exp_f32 v55, v55
    v_exp_f32 v56, v56
    v_exp_f32 v57, v57
    v_exp_f32 v58, v58
    v_exp_f32 v59, v59
    ds_read_b128 v[28:31], v5 offset:6144
    ds_read_b128 v[32:35], v5 offset:7168
    v_cvt_pk_bf16_f32 v112, v52, v53
    v_cvt_pk_bf16_f32 v113, v54, v55
    v_cvt_pk_bf16_f32 v114, v56, v57
    v_cvt_pk_bf16_f32 v115, v58, v59
    s_waitcnt lgkmcnt(2)
    s_nop 0
    v_mfma_f32_16x16x32_bf16 v[160:163], v[20:23], v[112:115], v[160:163]
    v_mfma_f32_16x16x32_bf16 v[164:167], v[24:27], v[112:115], v[164:167]
    v_fma_f32 v60, v60, v157, v158
    v_fma_f32 v61, v61, v157, v158
    v_fma_f32 v62, v62, v157, v158
    v_fma_f32 v63, v63, v157, v158
    v_fma_f32 v64, v64, v157, v158
    v_fma_f32 v65, v65, v157, v158
    v_fma_f32 v66, v66, v157, v158
    v_fma_f32 v67, v67, v157, v158
    v_exp_f32 v60, v60
    v_exp_f32 v61, v61
    v_exp_f32 v62, v62
    v_exp_f32 v63, v63
    v_exp_f32 v64, v64
    v_exp_f32 v65, v65
    v_exp_f32 v66, v66
    v_exp_f32 v67, v67
    ds_read_b128 v[20:23], v5 offset:8192
    ds_read_b128 v[24:27], v5 offset:9216
    v_cvt_pk_bf16_f32 v116, v60, v61
    v_cvt_pk_bf16_f32 v117, v62, v63
    v_cvt_pk_bf16_f32 v118, v64, v65
    v_cvt_pk_bf16_f32 v119, v66, v67
    s_waitcnt lgkmcnt(2)
    s_nop 0
    v_mfma_f32_16x16x32_bf16 v[160:163], v[28:31], v[116:119], v[160:163]
    v_mfma_f32_16x16x32_bf16 v[164:167], v[32:35], v[116:119], v[164:167]
    v_fma_f32 v68, v68, v157, v158
    v_fma_f32 v69, v69, v157, v158
    v_fma_f32 v70, v70, v157, v158
    v_fma_f32 v71, v71, v157, v158
    v_fma_f32 v72, v72, v157, v158
    v_fma_f32 v73, v73, v157, v158
    v_fma_f32 v74, v74, v157, v158
    v_fma_f32 v75, v75, v157, v158
    v_exp_f32 v68, v68
    v_exp_f32 v69, v69
    v_exp_f32 v70, v70
    v_exp_f32 v71, v71
    v_exp_f32 v72, v72
    v_exp_f32 v73, v73
    v_exp_f32 v74, v74
    v_exp_f32 v75, v75
    ds_read_b128 v[28:31], v5 offset:10240
    ds_read_b128 v[32:35], v5 offset:11264
    v_cvt_pk_bf16_f32 v120, v68, v69
    v_cvt_pk_bf16_f32 v121, v70, v71
    v_cvt_pk_bf16_f32 v122, v72, v73
    v_cvt_pk_bf16_f32 v123, v74, v75
    s_waitcnt lgkmcnt(2)
    s_nop 0
    v_mfma_f32_16x16x32_bf16 v[160:163], v[20:23], v[120:123], v[160:163]
    v_mfma_f32_16x16x32_bf16 v[164:167], v[24:27], v[120:123], v[164:167]
    s_mov_b32 s85, 11272192
    s_mov_b64 exec, 0x7fff
    buffer_load_dword v253, v232, s[28:31], s85 offen sc1
    s_mov_b64 exec, -1
    v_fma_f32 v76, v76, v157, v158
    v_fma_f32 v77, v77, v157, v158
    v_fma_f32 v78, v78, v157, v158
    v_fma_f32 v79, v79, v157, v158
    v_fma_f32 v80, v80, v157, v158
    v_fma_f32 v81, v81, v157, v158
    v_fma_f32 v82, v82, v157, v158
    v_fma_f32 v83, v83, v157, v158
    v_exp_f32 v76, v76
    v_exp_f32 v77, v77
    v_exp_f32 v78, v78
    v_exp_f32 v79, v79
    v_exp_f32 v80, v80
    v_exp_f32 v81, v81
    v_exp_f32 v82, v82
    v_exp_f32 v83, v83
    ds_read_b128 v[20:23], v5 offset:12288
    ds_read_b128 v[24:27], v5 offset:13312
    v_cvt_pk_bf16_f32 v124, v76, v77
    v_cvt_pk_bf16_f32 v125, v78, v79
    v_cvt_pk_bf16_f32 v126, v80, v81
    v_cvt_pk_bf16_f32 v127, v82, v83
    s_waitcnt lgkmcnt(2)
    s_nop 0
    v_mfma_f32_16x16x32_bf16 v[160:163], v[28:31], v[124:127], v[160:163]
    v_mfma_f32_16x16x32_bf16 v[164:167], v[32:35], v[124:127], v[164:167]
    v_fma_f32 v84, v84, v157, v158
    v_fma_f32 v85, v85, v157, v158
    v_fma_f32 v86, v86, v157, v158
    v_fma_f32 v87, v87, v157, v158
    v_fma_f32 v88, v88, v157, v158
    v_fma_f32 v89, v89, v157, v158
    v_fma_f32 v90, v90, v157, v158
    v_fma_f32 v91, v91, v157, v158
    v_exp_f32 v84, v84
    v_exp_f32 v85, v85
    v_exp_f32 v86, v86
    v_exp_f32 v87, v87
    v_exp_f32 v88, v88
    v_exp_f32 v89, v89
    v_exp_f32 v90, v90
    v_exp_f32 v91, v91
    ds_read_b128 v[28:31], v5 offset:14336
    ds_read_b128 v[32:35], v5 offset:15360
    v_cvt_pk_bf16_f32 v128, v84, v85
    v_cvt_pk_bf16_f32 v129, v86, v87
    v_cvt_pk_bf16_f32 v130, v88, v89
    v_cvt_pk_bf16_f32 v131, v90, v91
    s_waitcnt lgkmcnt(2)
    s_nop 0
    v_mfma_f32_16x16x32_bf16 v[160:163], v[20:23], v[128:131], v[160:163]
    v_mfma_f32_16x16x32_bf16 v[164:167], v[24:27], v[128:131], v[164:167]
    s_waitcnt vmcnt(0)
    v_cmp_ne_u32 s[96:97], s84, v253
    s_cmp_ge_u32 s2, 224
    s_cbranch_scc1 ex_57
    s_and_b64 s[96:97], s[96:97], 0x7fff
    s_cbranch_scc1 ex_57
    s_add_u32 m0, s36, 0
    s_nop 0
    buffer_load_dwordx4 v4, s[20:23], s35 offen sc1 lds
    buffer_load_dwordx4 v4, s[20:23], s35 offen offset:1024 sc1 lds
    s_add_u32 s35, s35, 2048
    s_add_u32 m0, s36, 32768
    s_nop 0
    buffer_load_dwordx4 v4, s[20:23], s35 offen sc1 lds
    buffer_load_dwordx4 v4, s[20:23], s35 offen offset:1024 sc1 lds
    s_add_u32 s35, s35, 2048
    s_mov_b32 s98, 1
ex_57:
    v_fma_f32 v92, v92, v157, v158
    v_fma_f32 v93, v93, v157, v158
    v_fma_f32 v94, v94, v157, v158
    v_fma_f32 v95, v95, v157, v158
    v_fma_f32 v96, v96, v157, v158
    v_fma_f32 v97, v97, v157, v158
    v_fma_f32 v98, v98, v157, v158
    v_fma_f32 v99, v99, v157, v158
    v_exp_f32 v92, v92
    v_exp_f32 v93, v93
    v_exp_f32 v94, v94
    v_exp_f32 v95, v95
    v_exp_f32 v96, v96
    v_exp_f32 v97, v97
    v_exp_f32 v98, v98
    v_exp_f32 v99, v99
    ds_read_b128 v[20:23], v5 offset:16384
    ds_read_b128 v[24:27], v5 offset:17408
    s_nop 0
    v_cvt_pk_bf16_f32 v132, v92, v93
    v_cvt_pk_bf16_f32 v133, v94, v95
    v_cvt_pk_bf16_f32 v134, v96, v97
    v_cvt_pk_bf16_f32 v135, v98, v99
    s_waitcnt lgkmcnt(2)
    s_nop 0
    v_mfma_f32_16x16x32_bf16 v[160:163], v[28:31], v[132:135], v[160:163]
    v_mfma_f32_16x16x32_bf16 v[164:167], v[32:35], v[132:135], v[164:167]
    v_fma_f32 v100, v100, v157, v158
    v_fma_f32 v101, v101, v157, v158
    v_fma_f32 v102, v102, v157, v158
    v_fma_f32 v103, v103, v157, v158
    v_exp_f32 v100, v100
    v_exp_f32 v101, v101
    v_exp_f32 v102, v102
    v_exp_f32 v103, v103
    s_nop 0
    v_cvt_pk_bf16_f32 v136, v100, v101
    v_cvt_pk_bf16_f32 v137, v102, v103
    s_waitcnt lgkmcnt(0)
    s_nop 0
    v_mfma_f32_16x16x32_bf16 v[160:163], v[20:23], v[136:139], v[160:163]
    v_mfma_f32_16x16x32_bf16 v[164:167], v[24:27], v[136:139], v[164:167]
    s_branch p2_out
p2_odd:
    v_mov_b32 v104, 0
    v_mov_b32 v105, 0
    v_fma_f32 v36, v36, v157, v158
    v_fma_f32 v37, v37, v157, v158
    v_fma_f32 v38, v38, v157, v158
    v_fma_f32 v39, v39, v157, v158
    v_exp_f32 v36, v36
    v_exp_f32 v37, v37
    v_exp_f32 v38, v38
    v_exp_f32 v39, v39
    ds_read_b128 v[28:31], v5 offset:2048
    ds_read_b128 v[32:35], v5 offset:3072
    v_cvt_pk_bf16_f32 v106, v36, v37
    v_cvt_pk_bf16_f32 v107, v38, v39
    s_waitcnt lgkmcnt(2)
    s_nop 0
    v_mfma_f32_16x16x32_bf16 v[160:163], v[20:23], v[104:107], 0
    v_mfma_f32_16x16x32_bf16 v[164:167], v[24:27], v[104:107], 0
    v_fma_f32 v40, v40, v157, v158
    v_fma_f32 v41, v41, v157, v158
    v_fma_f32 v42, v42, v157, v158
    v_fma_f32 v43, v43, v157, v158
    v_fma_f32 v44, v44, v157, v158
    v_fma_f32 v45, v45, v157, v158
    v_fma_f32 v46, v46, v157, v158
    v_fma_f32 v47, v47, v157, v158
    v_exp_f32 v40, v40
    v_exp_f32 v41, v41
    v_exp_f32 v42, v42
    v_exp_f32 v43, v43
    v_exp_f32 v44, v44
    v_exp_f32 v45, v45
    v_exp_f32 v46, v46
    v_exp_f32 v47, v47
    ds_read_b128 v[20:23], v5 offset:4096
    ds_read_b128 v[24:27], v5 offset:5120
    v_cvt_pk_bf16_f32 v108, v40, v41
    v_cvt_pk_bf16_f32 v109, v42, v43
    v_cvt_pk_bf16_f32 v110, v44, v45
    v_cvt_pk_bf16_f32 v111, v46, v47
    s_waitcnt lgkmcnt(2)
    s_nop 0
    v_mfma_f32_16x16x32_bf16 v[160:163], v[28:31], v[108:111], v[160:163]
    v_mfma_f32_16x16x32_bf16 v[164:167], v[32:35], v[108:111], v[164:167]
    v_fma_f32 v48, v48, v157, v158
    v_fma_f32 v49, v49, v157, v158
    v_fma_f32 v50, v50, v157, v158
    v_fma_f32 v51, v51, v157, v158
    v_fma_f32 v52, v52, v157, v158
    v_fma_f32 v53, v53, v157, v158
    v_fma_f32 v54, v54, v157, v158
    v_fma_f32 v55, v55, v157, v158
    v_exp_f32 v48, v48
    v_exp_f32 v49, v49
    v_exp_f32 v50, v50
    v_exp_f32 v51, v51
    v_exp_f32 v52, v52
    v_exp_f32 v53, v53
    v_exp_f32 v54, v54
    v_exp_f32 v55, v55
    ds_read_b128 v[28:31], v5 offset:6144
    ds_read_b128 v[32:35], v5 offset:7168
    v_cvt_pk_bf16_f32 v112, v48, v49
    v_cvt_pk_bf16_f32 v113, v50, v51
    v_cvt_pk_bf16_f32 v114, v52, v53
    v_cvt_pk_bf16_f32 v115, v54, v55
    s_waitcnt lgkmcnt(2)
    s_nop 0
    v_mfma_f32_16x16x32_bf16 v[160:163], v[20:23], v[112:115], v[160:163]
    v_mfma_f32_16x16x32_bf16 v[164:167], v[24:27], v[112:115], v[164:167]
    v_fma_f32 v56, v56, v157, v158
    v_fma_f32 v57, v57, v157, v158
    v_fma_f32 v58, v58, v157, v158
    v_fma_f32 v59, v59, v157, v158
    v_fma_f32 v60, v60, v157, v158
    v_fma_f32 v61, v61, v157, v158
    v_fma_f32 v62, v62, v157, v158
    v_fma_f32 v63, v63, v157, v158
    v_exp_f32 v56, v56
    v_exp_f32 v57, v57
    v_exp_f32 v58, v58
    v_exp_f32 v59, v59
    v_exp_f32 v60, v60
    v_exp_f32 v61, v61
    v_exp_f32 v62, v62
    v_exp_f32 v63, v63
    ds_read_b128 v[20:23], v5 offset:8192
    ds_read_b128 v[24:27], v5 offset:9216
    v_cvt_pk_bf16_f32 v116, v56, v57
    v_cvt_pk_bf16_f32 v117, v58, v59
    v_cvt_pk_bf16_f32 v118, v60, v61
    v_cvt_pk_bf16_f32 v119, v62, v63
    s_waitcnt lgkmcnt(2)
    s_nop 0
    v_mfma_f32_16x16x32_bf16 v[160:163], v[28:31], v[116:119], v[160:163]
    v_mfma_f32_16x16x32_bf16 v[164:167], v[32:35], v[116:119], v[164:167]
    v_fma_f32 v64, v64, v157, v158
    v_fma_f32 v65, v65, v157, v158
    v_fma_f32 v66, v66, v157, v158
    v_fma_f32 v67, v67, v157, v158
    v_fma_f32 v68, v68, v157, v158
    v_fma_f32 v69, v69, v157, v158
    v_fma_f32 v70, v70, v157, v158
    v_fma_f32 v71, v71, v157, v158
    v_exp_f32 v64, v64
    v_exp_f32 v65, v65
    v_exp_f32 v66, v66
    v_exp_f32 v67, v67
    v_exp_f32 v68, v68
    v_exp_f32 v69, v69
    v_exp_f32 v70, v70
    v_exp_f32 v71, v71
    ds_read_b128 v[28:31], v5 offset:10240
    ds_read_b128 v[32:35], v5 offset:11264
    v_cvt_pk_bf16_f32 v120, v64, v65
    v_cvt_pk_bf16_f32 v121, v66, v67
    v_cvt_pk_bf16_f32 v122, v68, v69
    v_cvt_pk_bf16_f32 v123, v70, v71
    s_waitcnt lgkmcnt(2)
    s_nop 0
    v_mfma_f32_16x16x32_bf16 v[160:163], v[20:23], v[120:123], v[160:163]
    v_mfma_f32_16x16x32_bf16 v[164:167], v[24:27], v[120:123], v[164:167]
    s_mov_b32 s85, 11272192
    s_mov_b64 exec, 0x7fff
    buffer_load_dword v253, v232, s[28:31], s85 offen sc1
    s_mov_b64 exec, -1
    v_fma_f32 v72, v72, v157, v158
    v_fma_f32 v73, v73, v157, v158
    v_fma_f32 v74, v74, v157, v158
    v_fma_f32 v75, v75, v157, v158
    v_fma_f32 v76, v76, v157, v158
    v_fma_f32 v77, v77, v157, v158
    v_fma_f32 v78, v78, v157, v158
    v_fma_f32 v79, v79, v157, v158
    v_exp_f32 v72, v72
    v_exp_f32 v73, v73
    v_exp_f32 v74, v74
    v_exp_f32 v75, v75
    v_exp_f32 v76, v76
    v_exp_f32 v77, v77
    v_exp_f32 v78, v78
    v_exp_f32 v79, v79
    ds_read_b128 v[20:23], v5 offset:12288
    ds_read_b128 v[24:27], v5 offset:13312
    v_cvt_pk_bf16_f32 v124, v72, v73
    v_cvt_pk_bf16_f32 v125, v74, v75
    v_cvt_pk_bf16_f32 v126, v76, v77
    v_cvt_pk_bf16_f32 v127, v78, v79
    s_waitcnt lgkmcnt(2)
    s_nop 0
    v_mfma_f32_16x16x32_bf16 v[160:163], v[28:31], v[124:127], v[160:163]
    v_mfma_f32_16x16x32_bf16 v[164:167], v[32:35], v[124:127], v[164:167]
    v_fma_f32 v80, v80, v157, v158
    v_fma_f32 v81, v81, v157, v158
    v_fma_f32 v82, v82, v157, v158
    v_fma_f32 v83, v83, v157, v158
    v_fma_f32 v84, v84, v157, v158
    v_fma_f32 v85, v85, v157, v158
    v_fma_f32 v86, v86, v157, v158
    v_fma_f32 v87, v87, v157, v158
    v_exp_f32 v80, v80
    v_exp_f32 v81, v81
    v_exp_f32 v82, v82
    v_exp_f32 v83, v83
    v_exp_f32 v84, v84
    v_exp_f32 v85, v85
    v_exp_f32 v86, v86
    v_exp_f32 v87, v87
    ds_read_b128 v[28:31], v5 offset:14336
    ds_read_b128 v[32:35], v5 offset:15360
    v_cvt_pk_bf16_f32 v128, v80, v81
    v_cvt_pk_bf16_f32 v129, v82, v83
    v_cvt_pk_bf16_f32 v130, v84, v85
    v_cvt_pk_bf16_f32 v131, v86, v87
    s_waitcnt lgkmcnt(2)
    s_nop 0
    v_mfma_f32_16x16x32_bf16 v[160:163], v[20:23], v[128:131], v[160:163]
    v_mfma_f32_16x16x32_bf16 v[164:167], v[24:27], v[128:131], v[164:167]
    s_waitcnt vmcnt(0)
    v_cmp_ne_u32 s[96:97], s84, v253
    s_cmp_ge_u32 s2, 224
    s_cbranch_scc1 ex_58
    s_and_b64 s[96:97], s[96:97], 0x7fff
    s_cbranch_scc1 ex_58
    s_add_u32 m0, s36, 0
    s_nop 0
    buffer_load_dwordx4 v4, s[20:23], s35 offen sc1 lds
    buffer_load_dwordx4 v4, s[20:23], s35 offen offset:1024 sc1 lds
    s_add_u32 s35, s35, 2048
    s_add_u32 m0, s36, 32768
    s_nop 0
    buffer_load_dwordx4 v4, s[20:23], s35 offen sc1 lds
    buffer_load_dwordx4 v4, s[20:23], s35 offen offset:1024 sc1 lds
    s_add_u32 s35, s35, 2048
    s_mov_b32 s98, 1
ex_58:
    v_fma_f32 v88, v88, v157, v158
    v_fma_f32 v89, v89, v157, v158
    v_fma_f32 v90, v90, v157, v158
    v_fma_f32 v91, v91, v157, v158
    v_fma_f32 v92, v92, v157, v158
    v_fma_f32 v93, v93, v157, v158
    v_fma_f32 v94, v94, v157, v158
    v_fma_f32 v95, v95, v157, v158
    v_exp_f32 v88, v88
    v_exp_f32 v89, v89
    v_exp_f32 v90, v90
    v_exp_f32 v91, v91
    v_exp_f32 v92, v92
    v_exp_f32 v93, v93
    v_exp_f32 v94, v94
    v_exp_f32 v95, v95
    ds_read_b128 v[20:23], v5 offset:16384
    ds_read_b128 v[24:27], v5 offset:17408
    s_nop 0
    v_cvt_pk_bf16_f32 v132, v88, v89
    v_cvt_pk_bf16_f32 v133, v90, v91
    v_cvt_pk_bf16_f32 v134, v92, v93
    v_cvt_pk_bf16_f32 v135, v94, v95
    s_waitcnt lgkmcnt(2)
    s_nop 0
    v_mfma_f32_16x16x32_bf16 v[160:163], v[28:31], v[132:135], v[160:163]
    v_mfma_f32_16x16x32_bf16 v[164:167], v[32:35], v[132:135], v[164:167]
    v_fma_f32 v96, v96, v157, v158
    v_fma_f32 v97, v97, v157, v158
    v_fma_f32 v98, v98, v157, v158
    v_fma_f32 v99, v99, v157, v158
    v_fma_f32 v100, v100, v157, v158
    v_fma_f32 v101, v101, v157, v158
    v_fma_f32 v102, v102, v157, v158
    v_fma_f32 v103, v103, v157, v158
    v_exp_f32 v96, v96
    v_exp_f32 v97, v97
    v_exp_f32 v98, v98
    v_exp_f32 v99, v99
    v_exp_f32 v100, v100
    v_exp_f32 v101, v101
    v_exp_f32 v102, v102
    v_exp_f32 v103, v103
    s_nop 0
    v_cvt_pk_bf16_f32 v136, v96, v97
    v_cvt_pk_bf16_f32 v137, v98, v99
    v_cvt_pk_bf16_f32 v138, v100, v101
    v_cvt_pk_bf16_f32 v139, v102, v103
    s_waitcnt lgkmcnt(0)
    s_nop 0
    v_mfma_f32_16x16x32_bf16 v[160:163], v[20:23], v[136:139], v[160:163]
    v_mfma_f32_16x16x32_bf16 v[164:167], v[24:27], v[136:139], v[164:167]
p2_out:
    v_mov_b32 v140, 0
    s_lshl_b32 s42, s40, 12
    v_add_u32 v7, s42, v240
    v_add_u32 v8, 65536, v7
    s_mov_b32 exec_lo, 0
    s_mov_b32 exec_hi, 0xffff0000
    v_mov_b32 v140, v164
    s_mov_b64 exec, -1
    v_mov_b32 v141, v140
    v_mov_b32 v142, v140
    s_nop 1
    v_permlane16_swap_b32 v141, v142
    s_nop 1
    v_add_f32 v140, v141, v142
    v_mov_b32 v141, v140
    v_mov_b32 v142, v140
    s_nop 1
    v_permlane32_swap_b32 v141, v142
    s_nop 1
    v_add_f32 v140, v141, v142
    v_rcp_f32 v140, v140
    s_nop 0
    v_mul_f32 v160, v140, v160
    v_mul_f32 v161, v140, v161
    v_mul_f32 v162, v140, v162
    v_mul_f32 v163, v140, v163
    v_mul_f32 v164, v140, v164
    v_mul_f32 v165, v140, v165
    v_mul_f32 v166, v140, v166
    v_mul_f32 v167, v140, v167
    v_cvt_pk_bf16_f32 v144, v160, v161
    v_cvt_pk_bf16_f32 v145, v162, v163
    v_cvt_pk_bf16_f32 v146, v164, v165
    v_cvt_pk_bf16_f32 v147, v166, v167
    buffer_store_dwordx2 v[144:145], v6, s[28:31], s60 offen sc1
    s_mov_b32 exec_hi, 0x0000ffff
    buffer_store_dwordx2 v[146:147], v6, s[28:31], s60 offen offset:512 sc1
    s_mov_b32 exec_hi, -1
    s_cmp_lt_u32 s2, 224
    s_cbranch_scc1 p3go_59
    s_waitcnt vmcnt(0)
    s_barrier
    s_cmp_lg_u32 s19, 0
    s_cbranch_scc1 pub_60
    s_lshl_b32 s85, s2, 7
    s_add_u32 s85, s85, 11337728
    v_mov_b32 v252, 0
    v_mov_b32 v253, s84
    s_mov_b64 exec, 1
    buffer_store_dword v253, v252, s[28:31], s85 offen sc1
    s_mov_b64 exec, -1
pub_60:
    s_endpgm
p3go_59:
    s_lshl_b32 s42, s41, 13
    s_add_u32 s42, s42, 16384
    s_add_u32 s43, s42, 65536
    v_add_u32 v16, s43, v236
    v_add_u32 v12, s42, v236
    v_add_u32 v17, s43, v237
    v_add_u32 v13, s42, v237
    v_add_u32 v18, s43, v238
    v_add_u32 v14, s42, v238
    v_add_u32 v19, s43, v239
    v_add_u32 v15, s42, v239
    s_lshl_b32 s39, s17, 3
    s_lshl_b32 s42, s40, 1
    s_add_u32 s39, s39, s42
    s_lshl_b32 s42, s39, 4
    v_add_u32 v24, s42, v2
    v_lshlrev_b32 v24, 7, v24
    v_lshl_add_u32 v24, v3, 5, v24
    s_mov_b32 s46, 11403264
    s_lshl_b32 s45, s33, 8
    s_add_u32 s45, s45, 11699968
    v_xor_b32 v203, 16, v243
    s_cmp_eq_u32 s98, 1
    s_cbranch_scc1 sp3_61
    s_mov_b64 exec, 0x7fff
    s_mov_b32 s85, 11272192
    s_mov_b32 s93, 0
pol_62:
    buffer_load_dword v253, v232, s[28:31], s85 offen sc1
    s_add_u32 s93, s93, 1
    s_waitcnt vmcnt(0)
    v_cmp_ne_u32 vcc, s84, v253
    s_cmp_lt_u32 s93, 0x20000
    s_cselect_b64 s[94:95], vcc, 0
    s_cmp_lg_u64 s[94:95], 0
    s_cbranch_scc1 pol_62
    s_mov_b64 exec, -1
    s_add_u32 m0, s36, 0
    s_nop 0
    buffer_load_dwordx4 v4, s[20:23], s35 offen sc1 lds
    buffer_load_dwordx4 v4, s[20:23], s35 offen offset:1024 sc1 lds
    s_add_u32 s35, s35, 2048
    s_add_u32 m0, s36, 32768
    s_nop 0
    buffer_load_dwordx4 v4, s[20:23], s35 offen sc1 lds
    buffer_load_dwordx4 v4, s[20:23], s35 offen offset:1024 sc1 lds
    s_add_u32 s35, s35, 2048
sp3_61:
    s_waitcnt vmcnt(2)
    s_barrier
    ds_read_b128 v[32:35], v7 offset:0
    ds_read_b128 v[36:39], v7 offset:2048
    ds_read_b64_tr_b16 v[48:49], v12 offset:0
    ds_read_b64_tr_b16 v[50:51], v12 offset:512
    ds_read_b64_tr_b16 v[52:53], v13 offset:0
    ds_read_b64_tr_b16 v[54:55], v13 offset:512
    ds_read_b64_tr_b16 v[56:57], v14 offset:0
    ds_read_b64_tr_b16 v[58:59], v14 offset:512
    ds_read_b64_tr_b16 v[60:61], v15 offset:0
    ds_read_b64_tr_b16 v[62:63], v15 offset:512
    s_waitcnt lgkmcnt(0)
    v_mfma_f32_16x16x32_bf16 v[92:95], v[48:51], v[32:35], 0
    ds_read_b128 v[40:43], v7 offset:1024
    ds_read_b128 v[44:47], v7 offset:3072
    v_mfma_f32_16x16x32_bf16 v[108:111], v[48:51], v[36:39], 0
    ds_read_b64_tr_b16 v[64:65], v12 offset:4096
    ds_read_b64_tr_b16 v[66:67], v12 offset:4608
    v_mfma_f32_16x16x32_bf16 v[96:99], v[52:55], v[32:35], 0
    ds_read_b64_tr_b16 v[68:69], v13 offset:4096
    ds_read_b64_tr_b16 v[70:71], v13 offset:4608
    v_mfma_f32_16x16x32_bf16 v[112:115], v[52:55], v[36:39], 0
    ds_read_b64_tr_b16 v[72:73], v14 offset:4096
    ds_read_b64_tr_b16 v[74:75], v14 offset:4608
    v_mfma_f32_16x16x32_bf16 v[100:103], v[56:59], v[32:35], 0
    ds_read_b64_tr_b16 v[76:77], v15 offset:4096
    ds_read_b64_tr_b16 v[78:79], v15 offset:4608
    v_mfma_f32_16x16x32_bf16 v[116:119], v[56:59], v[36:39], 0
    s_add_u32 m0, s36, 65536
    s_nop 0
    buffer_load_dwordx4 v4, s[20:23], s35 offen sc1 lds
    buffer_load_dwordx4 v4, s[20:23], s35 offen offset:1024 sc1 lds
    s_add_u32 s35, s35, 2048
    v_mfma_f32_16x16x32_bf16 v[104:107], v[60:63], v[32:35], 0
    v_mfma_f32_16x16x32_bf16 v[120:123], v[60:63], v[36:39], 0
    s_waitcnt vmcnt(2) lgkmcnt(0)
    s_barrier
    v_mfma_f32_16x16x32_bf16 v[92:95], v[64:67], v[40:43], v[92:95]
    ds_read_b128 v[32:35], v7 offset:32768
    ds_read_b128 v[36:39], v7 offset:34816
    ds_read_b64_tr_b16 v[48:49], v12 offset:32768
    v_mfma_f32_16x16x32_bf16 v[108:111], v[64:67], v[44:47], v[108:111]
    ds_read_b64_tr_b16 v[50:51], v12 offset:33280
    ds_read_b64_tr_b16 v[52:53], v13 offset:32768
    v_mfma_f32_16x16x32_bf16 v[96:99], v[68:71], v[40:43], v[96:99]
    ds_read_b64_tr_b16 v[54:55], v13 offset:33280
    ds_read_b64_tr_b16 v[56:57], v14 offset:32768
    v_mfma_f32_16x16x32_bf16 v[112:115], v[68:71], v[44:47], v[112:115]
    ds_read_b64_tr_b16 v[58:59], v14 offset:33280
    ds_read_b64_tr_b16 v[60:61], v15 offset:32768
    v_mfma_f32_16x16x32_bf16 v[100:103], v[72:75], v[40:43], v[100:103]
    ds_read_b64_tr_b16 v[62:63], v15 offset:33280
    s_add_u32 m0, s36, 98304
    s_nop 0
    buffer_load_dwordx4 v4, s[20:23], s35 offen sc1 lds
    buffer_load_dwordx4 v4, s[20:23], s35 offen offset:1024 sc1 lds
    s_add_u32 s35, s35, 2048
    v_mfma_f32_16x16x32_bf16 v[116:119], v[72:75], v[44:47], v[116:119]
    s_add_u32 m0, s37, 98304
    s_nop 0
    buffer_load_dwordx4 v204, s[24:27], s34 offen lds
    s_add_u32 s34, s34, s38
    s_add_u32 m0, s37, 102400
    s_nop 0
    buffer_load_dwordx4 v204, s[24:27], s34 offen lds
    s_add_u32 s34, s34, s38
    v_mfma_f32_16x16x32_bf16 v[104:107], v[76:79], v[40:43], v[104:107]
    v_mfma_f32_16x16x32_bf16 v[120:123], v[76:79], v[44:47], v[120:123]
    s_waitcnt lgkmcnt(0)
    v_mfma_f32_16x16x32_bf16 v[92:95], v[48:51], v[32:35], v[92:95]
    ds_read_b128 v[40:43], v7 offset:33792
    ds_read_b128 v[44:47], v7 offset:35840
    ds_read_b64_tr_b16 v[64:65], v12 offset:36864
    v_mfma_f32_16x16x32_bf16 v[108:111], v[48:51], v[36:39], v[108:111]
    ds_read_b64_tr_b16 v[66:67], v12 offset:37376
    ds_read_b64_tr_b16 v[68:69], v13 offset:36864
    v_mfma_f32_16x16x32_bf16 v[96:99], v[52:55], v[32:35], v[96:99]
    ds_read_b64_tr_b16 v[70:71], v13 offset:37376
    ds_read_b64_tr_b16 v[72:73], v14 offset:36864
    v_mfma_f32_16x16x32_bf16 v[112:115], v[52:55], v[36:39], v[112:115]
    ds_read_b64_tr_b16 v[74:75], v14 offset:37376
    ds_read_b64_tr_b16 v[76:77], v15 offset:36864
    v_mfma_f32_16x16x32_bf16 v[100:103], v[56:59], v[32:35], v[100:103]
    ds_read_b64_tr_b16 v[78:79], v15 offset:37376
    s_add_u32 m0, s36, 0
    s_nop 0
    buffer_load_dwordx4 v4, s[20:23], s35 offen sc1 lds
    buffer_load_dwordx4 v4, s[20:23], s35 offen offset:1024 sc1 lds
    s_add_u32 s35, s35, 2048
    v_mfma_f32_16x16x32_bf16 v[116:119], v[56:59], v[36:39], v[116:119]
    s_add_u32 m0, s37, 0
    s_nop 0
    buffer_load_dwordx4 v204, s[24:27], s34 offen lds
    s_add_u32 s34, s34, s38
    s_add_u32 m0, s37, 4096
    s_nop 0
    buffer_load_dwordx4 v204, s[24:27], s34 offen lds
    s_add_u32 s34, s34, s38
    v_mfma_f32_16x16x32_bf16 v[104:107], v[60:63], v[32:35], v[104:107]
    v_mfma_f32_16x16x32_bf16 v[120:123], v[60:63], v[36:39], v[120:123]
    s_waitcnt vmcnt(8) lgkmcnt(0)
    s_barrier
    v_mfma_f32_16x16x32_bf16 v[92:95], v[64:67], v[40:43], v[92:95]
    ds_read_b128 v[32:35], v8 offset:0
    ds_read_b128 v[36:39], v8 offset:2048
    v_mfma_f32_16x16x32_bf16 v[108:111], v[64:67], v[44:47], v[108:111]
    ds_read_b64_tr_b16 v[48:49], v16 offset:0
    ds_read_b64_tr_b16 v[50:51], v16 offset:512
    v_mfma_f32_16x16x32_bf16 v[96:99], v[68:71], v[40:43], v[96:99]
    ds_read_b64_tr_b16 v[52:53], v17 offset:0
    ds_read_b64_tr_b16 v[54:55], v17 offset:512
    v_mfma_f32_16x16x32_bf16 v[112:115], v[68:71], v[44:47], v[112:115]
    ds_read_b64_tr_b16 v[56:57], v18 offset:0
    ds_read_b64_tr_b16 v[58:59], v18 offset:512
    v_mfma_f32_16x16x32_bf16 v[100:103], v[72:75], v[40:43], v[100:103]
    ds_read_b64_tr_b16 v[60:61], v19 offset:0
    v_mfma_f32_16x16x32_bf16 v[116:119], v[72:75], v[44:47], v[116:119]
    ds_read_b64_tr_b16 v[62:63], v19 offset:512
    v_mfma_f32_16x16x32_bf16 v[104:107], v[76:79], v[40:43], v[104:107]
    v_mfma_f32_16x16x32_bf16 v[120:123], v[76:79], v[44:47], v[120:123]
    s_waitcnt lgkmcnt(0)
    v_mfma_f32_16x16x32_bf16 v[92:95], v[48:51], v[32:35], v[92:95]
    ds_read_b128 v[40:43], v8 offset:1024
    ds_read_b128 v[44:47], v8 offset:3072
    ds_read_b64_tr_b16 v[64:65], v16 offset:4096
    v_mfma_f32_16x16x32_bf16 v[108:111], v[48:51], v[36:39], v[108:111]
    ds_read_b64_tr_b16 v[66:67], v16 offset:4608
    ds_read_b64_tr_b16 v[68:69], v17 offset:4096
    ds_read_b64_tr_b16 v[70:71], v17 offset:4608
    v_mfma_f32_16x16x32_bf16 v[96:99], v[52:55], v[32:35], v[96:99]
    ds_read_b64_tr_b16 v[72:73], v18 offset:4096
    ds_read_b64_tr_b16 v[74:75], v18 offset:4608
    v_mfma_f32_16x16x32_bf16 v[112:115], v[52:55], v[36:39], v[112:115]
    ds_read_b64_tr_b16 v[76:77], v19 offset:4096
    ds_read_b64_tr_b16 v[78:79], v19 offset:4608
    v_mfma_f32_16x16x32_bf16 v[100:103], v[56:59], v[32:35], v[100:103]
    s_add_u32 m0, s36, 32768
    s_nop 0
    buffer_load_dwordx4 v4, s[20:23], s35 offen sc1 lds
    buffer_load_dwordx4 v4, s[20:23], s35 offen offset:1024 sc1 lds
    s_add_u32 s35, s35, 2048
    s_add_u32 m0, s37, 32768
    s_nop 0
    buffer_load_dwordx4 v204, s[24:27], s34 offen lds
    s_add_u32 s34, s34, s38
    v_mfma_f32_16x16x32_bf16 v[116:119], v[56:59], v[36:39], v[116:119]
    s_add_u32 m0, s37, 36864
    s_nop 0
    buffer_load_dwordx4 v204, s[24:27], s34 offen lds
    s_add_u32 s34, s34, s38
    s_cmp_lg_u32 s19, 0
    s_cbranch_scc1 pub_63
    s_lshl_b32 s85, s2, 7
    s_add_u32 s85, s85, 11337728
    v_mov_b32 v252, 0
    v_mov_b32 v253, s84
    s_mov_b64 exec, 1
    buffer_store_dword v253, v252, s[28:31], s85 offen sc1
    s_mov_b64 exec, -1
pub_63:
    v_mfma_f32_16x16x32_bf16 v[104:107], v[60:63], v[32:35], v[104:107]
    v_mfma_f32_16x16x32_bf16 v[120:123], v[60:63], v[36:39], v[120:123]
    s_waitcnt vmcnt(8) lgkmcnt(0)
    s_barrier
    v_mfma_f32_16x16x32_bf16 v[92:95], v[64:67], v[40:43], v[92:95]
    ds_read_b128 v[32:35], v8 offset:32768
    ds_read_b128 v[36:39], v8 offset:34816
    v_mfma_f32_16x16x32_bf16 v[108:111], v[64:67], v[44:47], v[108:111]
    ds_read_b64_tr_b16 v[48:49], v16 offset:32768
    ds_read_b64_tr_b16 v[50:51], v16 offset:33280
    v_mfma_f32_16x16x32_bf16 v[96:99], v[68:71], v[40:43], v[96:99]
    ds_read_b64_tr_b16 v[52:53], v17 offset:32768
    ds_read_b64_tr_b16 v[54:55], v17 offset:33280
    v_mfma_f32_16x16x32_bf16 v[112:115], v[68:71], v[44:47], v[112:115]
    ds_read_b64_tr_b16 v[56:57], v18 offset:32768
    ds_read_b64_tr_b16 v[58:59], v18 offset:33280
    v_mfma_f32_16x16x32_bf16 v[100:103], v[72:75], v[40:43], v[100:103]
    ds_read_b64_tr_b16 v[60:61], v19 offset:32768
    v_mfma_f32_16x16x32_bf16 v[116:119], v[72:75], v[44:47], v[116:119]
    ds_read_b64_tr_b16 v[62:63], v19 offset:33280
    v_mfma_f32_16x16x32_bf16 v[104:107], v[76:79], v[40:43], v[104:107]
    v_mfma_f32_16x16x32_bf16 v[120:123], v[76:79], v[44:47], v[120:123]
    s_waitcnt lgkmcnt(0)
    v_mfma_f32_16x16x32_bf16 v[92:95], v[48:51], v[32:35], v[92:95]
    ds_read_b128 v[40:43], v8 offset:33792
    ds_read_b128 v[44:47], v8 offset:35840
    ds_read_b64_tr_b16 v[64:65], v16 offset:36864
    v_mfma_f32_16x16x32_bf16 v[108:111], v[48:51], v[36:39], v[108:111]
    ds_read_b64_tr_b16 v[66:67], v16 offset:37376
    ds_read_b64_tr_b16 v[68:69], v17 offset:36864
    v_mfma_f32_16x16x32_bf16 v[96:99], v[52:55], v[32:35], v[96:99]
    ds_read_b64_tr_b16 v[70:71], v17 offset:37376
    ds_read_b64_tr_b16 v[72:73], v18 offset:36864
    v_mfma_f32_16x16x32_bf16 v[112:115], v[52:55], v[36:39], v[112:115]
    ds_read_b64_tr_b16 v[74:75], v18 offset:37376
    ds_read_b64_tr_b16 v[76:77], v19 offset:36864
    v_mfma_f32_16x16x32_bf16 v[100:103], v[56:59], v[32:35], v[100:103]
    ds_read_b64_tr_b16 v[78:79], v19 offset:37376
    s_add_u32 m0, s36, 65536
    s_nop 0
    buffer_load_dwordx4 v4, s[20:23], s35 offen sc1 lds
    buffer_load_dwordx4 v4, s[20:23], s35 offen offset:1024 sc1 lds
    s_add_u32 s35, s35, 2048
    v_mfma_f32_16x16x32_bf16 v[116:119], v[56:59], v[36:39], v[116:119]
    s_add_u32 m0, s37, 65536
    s_nop 0
    buffer_load_dwordx4 v204, s[24:27], s34 offen lds
    s_add_u32 s34, s34, s38
    s_add_u32 m0, s37, 69632
    s_nop 0
    buffer_load_dwordx4 v204, s[24:27], s34 offen lds
    s_add_u32 s34, s34, s38
    v_mfma_f32_16x16x32_bf16 v[104:107], v[60:63], v[32:35], v[104:107]
    v_mfma_f32_16x16x32_bf16 v[120:123], v[60:63], v[36:39], v[120:123]
    s_waitcnt vmcnt(8) lgkmcnt(0)
    s_barrier
    v_mfma_f32_16x16x32_bf16 v[92:95], v[64:67], v[40:43], v[92:95]
    ds_read_b128 v[32:35], v7 offset:0
    ds_read_b128 v[36:39], v7 offset:2048
    v_mfma_f32_16x16x32_bf16 v[108:111], v[64:67], v[44:47], v[108:111]
    ds_read_b64_tr_b16 v[48:49], v12 offset:0
    ds_read_b64_tr_b16 v[50:51], v12 offset:512
    v_mfma_f32_16x16x32_bf16 v[96:99], v[68:71], v[40:43], v[96:99]
    ds_read_b64_tr_b16 v[52:53], v13 offset:0
    ds_read_b64_tr_b16 v[54:55], v13 offset:512
    v_mfma_f32_16x16x32_bf16 v[112:115], v[68:71], v[44:47], v[112:115]
    ds_read_b64_tr_b16 v[56:57], v14 offset:0
    ds_read_b64_tr_b16 v[58:59], v14 offset:512
    v_mfma_f32_16x16x32_bf16 v[100:103], v[72:75], v[40:43], v[100:103]
    ds_read_b64_tr_b16 v[60:61], v15 offset:0
    ds_read_b64_tr_b16 v[62:63], v15 offset:512
    v_mfma_f32_16x16x32_bf16 v[116:119], v[72:75], v[44:47], v[116:119]
    buffer_load_dwordx4 v[180:183], v24, s[28:31], s46 offen offset:0 sc1
    buffer_load_dwordx4 v[184:187], v24, s[28:31], s46 offen offset:16 sc1
    buffer_load_dwordx4 v[188:191], v24, s[28:31], s46 offen offset:2048 sc1
    buffer_load_dwordx4 v[192:195], v24, s[28:31], s46 offen offset:2064 sc1
    buffer_load_dwordx4 v[164:167], v243, s[28:31], s45 offen offset:0 sc1
    buffer_load_dwordx4 v[168:171], v203, s[28:31], s45 offen offset:0 sc1
    buffer_load_dwordx4 v[172:175], v243, s[28:31], s45 offen offset:128 sc1
    buffer_load_dwordx4 v[176:179], v203, s[28:31], s45 offen offset:128 sc1
    s_load_dwordx2 s[4:5], s[0:1], 16
    s_load_dwordx2 s[6:7], s[0:1], 56
    s_load_dwordx2 s[8:9], s[0:1], 72
    v_mfma_f32_16x16x32_bf16 v[104:107], v[76:79], v[40:43], v[104:107]
    v_mfma_f32_16x16x32_bf16 v[120:123], v[76:79], v[44:47], v[120:123]
    s_waitcnt lgkmcnt(0)
    v_mfma_f32_16x16x32_bf16 v[92:95], v[48:51], v[32:35], v[92:95]
    ds_read_b128 v[40:43], v7 offset:1024
    ds_read_b128 v[44:47], v7 offset:3072
    v_mfma_f32_16x16x32_bf16 v[108:111], v[48:51], v[36:39], v[108:111]
    ds_read_b64_tr_b16 v[64:65], v12 offset:4096
    ds_read_b64_tr_b16 v[66:67], v12 offset:4608
    v_mfma_f32_16x16x32_bf16 v[96:99], v[52:55], v[32:35], v[96:99]
    ds_read_b64_tr_b16 v[68:69], v13 offset:4096
    ds_read_b64_tr_b16 v[70:71], v13 offset:4608
    v_mfma_f32_16x16x32_bf16 v[112:115], v[52:55], v[36:39], v[112:115]
    ds_read_b64_tr_b16 v[72:73], v14 offset:4096
    ds_read_b64_tr_b16 v[74:75], v14 offset:4608
    v_mfma_f32_16x16x32_bf16 v[100:103], v[56:59], v[32:35], v[100:103]
    ds_read_b64_tr_b16 v[76:77], v15 offset:4096
    v_mfma_f32_16x16x32_bf16 v[116:119], v[56:59], v[36:39], v[116:119]
    ds_read_b64_tr_b16 v[78:79], v15 offset:4608
    v_mfma_f32_16x16x32_bf16 v[104:107], v[60:63], v[32:35], v[104:107]
    v_mfma_f32_16x16x32_bf16 v[120:123], v[60:63], v[36:39], v[120:123]
    s_waitcnt vmcnt(12) lgkmcnt(0)
    s_barrier
    v_mfma_f32_16x16x32_bf16 v[92:95], v[64:67], v[40:43], v[92:95]
    ds_read_b128 v[32:35], v7 offset:32768
    ds_read_b128 v[36:39], v7 offset:34816
    v_mfma_f32_16x16x32_bf16 v[108:111], v[64:67], v[44:47], v[108:111]
    ds_read_b64_tr_b16 v[48:49], v12 offset:32768
    ds_read_b64_tr_b16 v[50:51], v12 offset:33280
    v_mfma_f32_16x16x32_bf16 v[96:99], v[68:71], v[40:43], v[96:99]
    ds_read_b64_tr_b16 v[52:53], v13 offset:32768
    ds_read_b64_tr_b16 v[54:55], v13 offset:33280
    v_mfma_f32_16x16x32_bf16 v[112:115], v[68:71], v[44:47], v[112:115]
    ds_read_b64_tr_b16 v[56:57], v14 offset:32768
    ds_read_b64_tr_b16 v[58:59], v14 offset:33280
    v_mfma_f32_16x16x32_bf16 v[100:103], v[72:75], v[40:43], v[100:103]
    ds_read_b64_tr_b16 v[60:61], v15 offset:32768
    ds_read_b64_tr_b16 v[62:63], v15 offset:33280
    v_mfma_f32_16x16x32_bf16 v[116:119], v[72:75], v[44:47], v[116:119]
    s_mul_i32 s16, s15, 9363
    s_lshr_b32 s16, s16, 16
    s_mul_i32 s69, s16, 7
    s_sub_u32 s69, s15, s69
    s_lshl_b32 s68, s14, 2
    s_add_u32 s68, s68, s16
    v_and_b32 v245, 1, v1
    v_lshlrev_b32 v245, 4, v245
    s_lshr_b32 s85, s68, 1
    v_add_u32 v245, s85, v245
    v_lshrrev_b32 v246, 1, v1
    v_lshl_add_u32 v245, v245, 3, v246
    v_lshlrev_b32 v245, 7, v245
    v_add_u32 v245, 65536, v245
    s_add_u32 s85, s68, 224
    s_lshl_b32 s85, s85, 7
    s_add_u32 s85, s85, 32768
    v_writelane_b32 v245, s85, 16
    s_lshl_b32 s70, s68, 2
    s_add_u32 s70, s70, s40
    s_mul_i32 s62, s70, 14336
    s_mul_i32 s63, s41, 7168
    s_add_u32 s62, s62, s63
    s_add_u32 s62, s62, 9437184
    s_add_u32 s63, s62, 4096
    s_lshl_b32 s85, s70, 4
    v_add_u32 v244, s85, v2
    v_lshlrev_b32 v246, 2, v244
    s_mov_b32 s64, 11665408
    s_mov_b32 s85, 11272192
    s_mov_b64 exec, 0x1ffff
    buffer_load_dword v253, v245, s[28:31], s85 offen sc1
    s_mov_b64 exec, -1
    v_mfma_f32_16x16x32_bf16 v[104:107], v[76:79], v[40:43], v[104:107]
    v_mfma_f32_16x16x32_bf16 v[120:123], v[76:79], v[44:47], v[120:123]
    s_waitcnt lgkmcnt(0)
    v_mfma_f32_16x16x32_bf16 v[92:95], v[48:51], v[32:35], v[92:95]
    ds_read_b128 v[40:43], v7 offset:33792
    ds_read_b128 v[44:47], v7 offset:35840
    v_mfma_f32_16x16x32_bf16 v[108:111], v[48:51], v[36:39], v[108:111]
    ds_read_b64_tr_b16 v[64:65], v12 offset:36864
    ds_read_b64_tr_b16 v[66:67], v12 offset:37376
    v_mfma_f32_16x16x32_bf16 v[96:99], v[52:55], v[32:35], v[96:99]
    ds_read_b64_tr_b16 v[68:69], v13 offset:36864
    ds_read_b64_tr_b16 v[70:71], v13 offset:37376
    v_mfma_f32_16x16x32_bf16 v[112:115], v[52:55], v[36:39], v[112:115]
    ds_read_b64_tr_b16 v[72:73], v14 offset:36864
    ds_read_b64_tr_b16 v[74:75], v14 offset:37376
    v_mfma_f32_16x16x32_bf16 v[100:103], v[56:59], v[32:35], v[100:103]
    ds_read_b64_tr_b16 v[76:77], v15 offset:36864
    v_mfma_f32_16x16x32_bf16 v[116:119], v[56:59], v[36:39], v[116:119]
    ds_read_b64_tr_b16 v[78:79], v15 offset:37376
    v_mfma_f32_16x16x32_bf16 v[104:107], v[60:63], v[32:35], v[104:107]
    v_mfma_f32_16x16x32_bf16 v[120:123], v[60:63], v[36:39], v[120:123]
    s_waitcnt vmcnt(9) lgkmcnt(0)
    s_barrier
    v_mfma_f32_16x16x32_bf16 v[92:95], v[64:67], v[40:43], v[92:95]
    ds_read_b128 v[32:35], v8 offset:0
    ds_read_b128 v[36:39], v8 offset:2048
    v_mfma_f32_16x16x32_bf16 v[108:111], v[64:67], v[44:47], v[108:111]
    ds_read_b64_tr_b16 v[48:49], v16 offset:0
    ds_read_b64_tr_b16 v[50:51], v16 offset:512
    v_mfma_f32_16x16x32_bf16 v[96:99], v[68:71], v[40:43], v[96:99]
    ds_read_b64_tr_b16 v[52:53], v17 offset:0
    ds_read_b64_tr_b16 v[54:55], v17 offset:512
    v_mfma_f32_16x16x32_bf16 v[112:115], v[68:71], v[44:47], v[112:115]
    ds_read_b64_tr_b16 v[56:57], v18 offset:0
    ds_read_b64_tr_b16 v[58:59], v18 offset:512
    v_mfma_f32_16x16x32_bf16 v[100:103], v[72:75], v[40:43], v[100:103]
    ds_read_b64_tr_b16 v[60:61], v19 offset:0
    ds_read_b64_tr_b16 v[62:63], v19 offset:512
    v_mfma_f32_16x16x32_bf16 v[116:119], v[72:75], v[44:47], v[116:119]
    s_waitcnt vmcnt(1)
    s_mov_b32 exec_lo, 0
    s_mov_b32 exec_hi, 0xffff0000
    v_mov_b32 v184, 0
    v_mov_b32 v185, 0
    v_mov_b32 v186, 0
    v_mov_b32 v187, 0
    v_mov_b32 v192, 0
    v_mov_b32 v193, 0
    v_mov_b32 v194, 0
    v_mov_b32 v195, 0
    s_mov_b64 exec, -1
    v_add_f32 v198, v180, v182
    v_add_f32 v199, v184, v186
    v_add_f32 v198, v198, v199
    v_mov_b32 v196, v198
    v_mov_b32 v197, v198
    s_nop 1
    v_permlane16_swap_b32 v196, v197
    s_nop 1
    v_add_f32 v198, v196, v197
    v_mov_b32 v196, v198
    v_mov_b32 v197, v198
    s_nop 1
    v_permlane32_swap_b32 v196, v197
    s_nop 1
    v_add_f32 v198, v196, v197
    v_mul_f32 v198, 0x3b124925, v198
    v_add_f32 v199, v181, v183
    v_add_f32 v199, v199, v185
    v_add_f32 v199, v199, v187
    v_mul_f32 v180, 0x3d000000, v180
    v_sub_f32 v180, v180, v198
    v_mul_f32 v182, 0x3d000000, v182
    v_sub_f32 v182, v182, v198
    v_mul_f32 v184, 0x3d000000, v184
    v_sub_f32 v184, v184, v198
    v_mul_f32 v186, 0x3d000000, v186
    v_sub_f32 v186, v186, v198
    v_mul_f32 v180, v180, v180
    v_fmac_f32 v180, v182, v182
    s_mov_b32 exec_hi, 0x0000ffff
    v_fmac_f32 v180, v184, v184
    v_fmac_f32 v180, v186, v186
    s_mov_b32 exec_hi, -1
    v_fmamk_f32 v199, v180, 0x42000000, v199
    v_mov_b32 v196, v199
    v_mov_b32 v197, v199
    s_nop 1
    v_permlane16_swap_b32 v196, v197
    s_nop 1
    v_add_f32 v199, v196, v197
    v_mov_b32 v196, v199
    v_mov_b32 v197, v199
    s_nop 1
    v_permlane32_swap_b32 v196, v197
    s_nop 1
    v_add_f32 v199, v196, v197
    v_mul_f32 v199, 0x3b124925, v199
    v_cvt_pk_bf16_f32 v198, 0, v198
    v_cvt_pk_bf16_f32 v199, 0, v199
    v_add_f32 v199, 0x3727c5ac, v199
    v_cvt_pk_bf16_f32 v199, 0, v199
    v_sqrt_f32 v199, v199
    v_sub_f32 v198, 0, v198
    v_cvt_pk_bf16_f32 v199, 0, v199
    v_rcp_f32 v199, v199
    s_nop 0
    v_rcp_f32 v146, v199
    v_mul_f32 v142, 0xc0135761, v199
    v_mul_f32 v144, v199, v199
    v_mul_f32 v144, v144, v199
    v_mul_f32 v144, 0xbdd2d3e8, v144
    v_mov_b32 v140, v198
    v_mov_b32 v141, v140
    v_mov_b32 v143, v142
    v_mov_b32 v145, v144
    v_mov_b32 v147, v146
    v_add_f32 v198, v188, v190
    v_add_f32 v199, v192, v194
    v_add_f32 v198, v198, v199
    v_mov_b32 v196, v198
    v_mov_b32 v197, v198
    s_nop 1
    v_permlane16_swap_b32 v196, v197
    s_nop 1
    v_add_f32 v198, v196, v197
    v_mov_b32 v196, v198
    v_mov_b32 v197, v198
    s_nop 1
    v_permlane32_swap_b32 v196, v197
    s_nop 1
    v_add_f32 v198, v196, v197
    v_mul_f32 v198, 0x3b124925, v198
    v_add_f32 v199, v189, v191
    v_add_f32 v199, v199, v193
    v_add_f32 v199, v199, v195
    v_mul_f32 v188, 0x3d000000, v188
    v_sub_f32 v188, v188, v198
    v_mul_f32 v190, 0x3d000000, v190
    v_sub_f32 v190, v190, v198
    v_mul_f32 v192, 0x3d000000, v192
    v_sub_f32 v192, v192, v198
    v_mul_f32 v194, 0x3d000000, v194
    v_sub_f32 v194, v194, v198
    v_mul_f32 v188, v188, v188
    v_fmac_f32 v188, v190, v190
    s_mov_b32 exec_hi, 0x0000ffff
    v_fmac_f32 v188, v192, v192
    v_fmac_f32 v188, v194, v194
    s_mov_b32 exec_hi, -1
    v_fmamk_f32 v199, v188, 0x42000000, v199
    v_mov_b32 v196, v199
    v_mov_b32 v197, v199
    s_nop 1
    v_permlane16_swap_b32 v196, v197
    s_nop 1
    v_add_f32 v199, v196, v197
    v_mov_b32 v196, v199
    v_mov_b32 v197, v199
    s_nop 1
    v_permlane32_swap_b32 v196, v197
    s_nop 1
    v_add_f32 v199, v196, v197
    v_mul_f32 v199, 0x3b124925, v199
    v_cvt_pk_bf16_f32 v198, 0, v198
    v_cvt_pk_bf16_f32 v199, 0, v199
    v_add_f32 v199, 0x3727c5ac, v199
    v_cvt_pk_bf16_f32 v199, 0, v199
    v_sqrt_f32 v199, v199
    v_sub_f32 v198, 0, v198
    v_cvt_pk_bf16_f32 v199, 0, v199
    v_rcp_f32 v199, v199
    s_nop 0
    v_rcp_f32 v154, v199
    v_mul_f32 v150, 0xc0135761, v199
    v_mul_f32 v152, v199, v199
    v_mul_f32 v152, v152, v199
    v_mul_f32 v152, 0xbdd2d3e8, v152
    v_mov_b32 v148, v198
    v_mov_b32 v149, v148
    v_mov_b32 v151, v150
    v_mov_b32 v153, v152
    v_mov_b32 v155, v154
    s_mul_i32 s42, s39, 57344
    s_lshl_b32 s43, s33, 11
    s_add_u32 s42, s42, s43
    s_add_u32 s42, s42, 11796480
    s_add_u32 s43, s42, 57344
    v_mfma_f32_16x16x32_bf16 v[104:107], v[76:79], v[40:43], v[104:107]
    v_mfma_f32_16x16x32_bf16 v[120:123], v[76:79], v[44:47], v[120:123]
    s_waitcnt lgkmcnt(0)
    v_mfma_f32_16x16x32_bf16 v[92:95], v[48:51], v[32:35], v[92:95]
    ds_read_b128 v[40:43], v8 offset:1024
    ds_read_b128 v[44:47], v8 offset:3072
    v_mfma_f32_16x16x32_bf16 v[108:111], v[48:51], v[36:39], v[108:111]
    ds_read_b64_tr_b16 v[64:65], v16 offset:4096
    ds_read_b64_tr_b16 v[66:67], v16 offset:4608
    v_mfma_f32_16x16x32_bf16 v[96:99], v[52:55], v[32:35], v[96:99]
    ds_read_b64_tr_b16 v[68:69], v17 offset:4096
    ds_read_b64_tr_b16 v[70:71], v17 offset:4608
    v_mfma_f32_16x16x32_bf16 v[112:115], v[52:55], v[36:39], v[112:115]
    ds_read_b64_tr_b16 v[72:73], v18 offset:4096
    ds_read_b64_tr_b16 v[74:75], v18 offset:4608
    v_mfma_f32_16x16x32_bf16 v[100:103], v[56:59], v[32:35], v[100:103]
    ds_read_b64_tr_b16 v[76:77], v19 offset:4096
    v_mfma_f32_16x16x32_bf16 v[116:119], v[56:59], v[36:39], v[116:119]
    ds_read_b64_tr_b16 v[78:79], v19 offset:4608
    v_mfma_f32_16x16x32_bf16 v[104:107], v[60:63], v[32:35], v[104:107]
    v_mfma_f32_16x16x32_bf16 v[120:123], v[60:63], v[36:39], v[120:123]
    s_waitcnt lgkmcnt(0)
    v_mfma_f32_16x16x32_bf16 v[92:95], v[64:67], v[40:43], v[92:95]
    v_mfma_f32_16x16x32_bf16 v[108:111], v[64:67], v[44:47], v[108:111]
    v_mfma_f32_16x16x32_bf16 v[96:99], v[68:71], v[40:43], v[96:99]
    v_mfma_f32_16x16x32_bf16 v[112:115], v[68:71], v[44:47], v[112:115]
    v_mfma_f32_16x16x32_bf16 v[100:103], v[72:75], v[40:43], v[100:103]
    v_mfma_f32_16x16x32_bf16 v[116:119], v[72:75], v[44:47], v[116:119]
    v_mfma_f32_16x16x32_bf16 v[104:107], v[76:79], v[40:43], v[104:107]
    v_mfma_f32_16x16x32_bf16 v[120:123], v[76:79], v[44:47], v[120:123]
    v_mov_b32 v6, v241
    s_and_b32 s85, s19, 1
    s_lshl_b32 s85, s85, 6
    v_xor_b32 v6, s85, v6
    v_xor_b32 v7, 64, v6
    s_lshl_b32 s66, s69, 7
    s_mul_i32 s65, s19, 50176
    s_add_u32 s65, s65, s66
    s_mul_i32 s67, s19, 7168
    s_mov_b32 s20, s4
    s_and_b32 s21, s5, 0xffff
    s_mov_b32 s22, 401408
    s_mov_b32 s23, 0x00020000
    s_barrier
    v_pk_fma_f32 v[92:93], v[164:165], v[140:141], v[92:93]
    s_mov_b32 m0, s67
    s_add_u32 s67, s67, 1024
    buffer_load_dwordx4 v6, s[20:23], s65 offen lds
    s_add_u32 s65, s65, 7168
    v_pk_fma_f32 v[94:95], v[166:167], v[140:141], v[94:95]
    s_mov_b32 m0, s67
    s_add_u32 s67, s67, 1024
    buffer_load_dwordx4 v7, s[20:23], s65 offen lds
    s_add_u32 s65, s65, 7168
    v_pk_fma_f32 v[96:97], v[168:169], v[140:141], v[96:97]
    s_mov_b32 m0, s67
    s_add_u32 s67, s67, 1024
    buffer_load_dwordx4 v6, s[20:23], s65 offen lds
    s_add_u32 s65, s65, 7168
    v_pk_fma_f32 v[98:99], v[170:171], v[140:141], v[98:99]
    s_mov_b32 m0, s67
    s_add_u32 s67, s67, 1024
    buffer_load_dwordx4 v7, s[20:23], s65 offen lds
    s_add_u32 s65, s65, 7168
    v_pk_fma_f32 v[100:101], v[172:173], v[140:141], v[100:101]
    s_mov_b32 m0, s67
    s_add_u32 s67, s67, 1024
    buffer_load_dwordx4 v6, s[20:23], s65 offen lds
    s_add_u32 s65, s65, 7168
    v_pk_fma_f32 v[102:103], v[174:175], v[140:141], v[102:103]
    s_mov_b32 m0, s67
    s_add_u32 s67, s67, 1024
    buffer_load_dwordx4 v7, s[20:23], s65 offen lds
    s_add_u32 s65, s65, 7168
    v_pk_fma_f32 v[104:105], v[176:177], v[140:141], v[104:105]
    s_mov_b32 m0, s67
    s_add_u32 s67, s67, 1024
    buffer_load_dwordx4 v6, s[20:23], s65 offen lds
    s_add_u32 s65, s65, 7168
    v_pk_fma_f32 v[106:107], v[178:179], v[140:141], v[106:107]
    s_waitcnt vmcnt(7)
    v_cmp_ne_u32 s[96:97], s84, v253
    v_pk_mul_f32 v[48:49], v[92:93], v[92:93]
    buffer_load_dwordx4 v[204:207], v240, s[28:31], s62 offen offset:0 sc1
    v_pk_mul_f32 v[50:51], v[94:95], v[94:95]
    buffer_load_dwordx4 v[208:211], v240, s[28:31], s62 offen offset:1024 sc1
    v_pk_mul_f32 v[52:53], v[96:97], v[96:97]
    buffer_load_dwordx4 v[212:215], v240, s[28:31], s62 offen offset:2048 sc1
    v_pk_mul_f32 v[54:55], v[98:99], v[98:99]
    buffer_load_dwordx4 v[216:219], v240, s[28:31], s62 offen offset:3072 sc1
    v_pk_mul_f32 v[56:57], v[100:101], v[100:101]
    buffer_load_dwordx4 v[220:223], v240, s[28:31], s63 offen offset:0 sc1
    v_pk_mul_f32 v[58:59], v[102:103], v[102:103]
    buffer_load_dwordx4 v[224:227], v240, s[28:31], s63 offen offset:1024 sc1
    v_pk_mul_f32 v[60:61], v[104:105], v[104:105]
    buffer_load_dwordx4 v[228:231], v240, s[28:31], s63 offen offset:2048 sc1
    v_pk_mul_f32 v[62:63], v[106:107], v[106:107]
    buffer_load_dword v247, v246, s[28:31], s64 offen sc1
    v_pk_fma_f32 v[48:49], v[48:49], v[144:145], v[142:143]
    v_pk_fma_f32 v[50:51], v[50:51], v[144:145], v[142:143]
    v_pk_fma_f32 v[52:53], v[52:53], v[144:145], v[142:143]
    v_pk_fma_f32 v[54:55], v[54:55], v[144:145], v[142:143]
    v_pk_fma_f32 v[56:57], v[56:57], v[144:145], v[142:143]
    v_pk_fma_f32 v[58:59], v[58:59], v[144:145], v[142:143]
    v_pk_fma_f32 v[60:61], v[60:61], v[144:145], v[142:143]
    v_pk_fma_f32 v[62:63], v[62:63], v[144:145], v[142:143]
    v_pk_mul_f32 v[48:49], v[48:49], v[92:93]
    v_pk_mul_f32 v[50:51], v[50:51], v[94:95]
    v_pk_mul_f32 v[52:53], v[52:53], v[96:97]
    v_pk_mul_f32 v[54:55], v[54:55], v[98:99]
    v_pk_mul_f32 v[56:57], v[56:57], v[100:101]
    v_pk_mul_f32 v[58:59], v[58:59], v[102:103]
    v_pk_mul_f32 v[60:61], v[60:61], v[104:105]
    v_pk_mul_f32 v[62:63], v[62:63], v[106:107]
    v_exp_f32 v48, v48
    v_exp_f32 v49, v49
    v_exp_f32 v50, v50
    v_exp_f32 v51, v51
    v_exp_f32 v52, v52
    v_exp_f32 v53, v53
    v_exp_f32 v54, v54
    v_exp_f32 v55, v55
    v_exp_f32 v56, v56
    v_exp_f32 v57, v57
    v_exp_f32 v58, v58
    v_exp_f32 v59, v59
    v_exp_f32 v60, v60
    v_exp_f32 v61, v61
    v_exp_f32 v62, v62
    v_exp_f32 v63, v63
    v_pk_fma_f32 v[48:49], v[48:49], v[146:147], v[146:147]
    v_pk_fma_f32 v[50:51], v[50:51], v[146:147], v[146:147]
    v_pk_fma_f32 v[52:53], v[52:53], v[146:147], v[146:147]
    v_pk_fma_f32 v[54:55], v[54:55], v[146:147], v[146:147]
    v_pk_fma_f32 v[56:57], v[56:57], v[146:147], v[146:147]
    v_pk_fma_f32 v[58:59], v[58:59], v[146:147], v[146:147]
    v_pk_fma_f32 v[60:61], v[60:61], v[146:147], v[146:147]
    v_pk_fma_f32 v[62:63], v[62:63], v[146:147], v[146:147]
    v_rcp_f32 v48, v48
    v_rcp_f32 v49, v49
    v_rcp_f32 v50, v50
    v_rcp_f32 v51, v51
    v_rcp_f32 v52, v52
    v_rcp_f32 v53, v53
    v_rcp_f32 v54, v54
    v_rcp_f32 v55, v55
    v_rcp_f32 v56, v56
    v_rcp_f32 v57, v57
    v_rcp_f32 v58, v58
    v_rcp_f32 v59, v59
    v_rcp_f32 v60, v60
    v_rcp_f32 v61, v61
    v_rcp_f32 v62, v62
    v_rcp_f32 v63, v63
    v_pk_mul_f32 v[92:93], v[92:93], v[48:49]
    v_pk_mul_f32 v[94:95], v[94:95], v[50:51]
    v_pk_mul_f32 v[96:97], v[96:97], v[52:53]
    v_pk_mul_f32 v[98:99], v[98:99], v[54:55]
    v_pk_mul_f32 v[100:101], v[100:101], v[56:57]
    v_pk_mul_f32 v[102:103], v[102:103], v[58:59]
    v_pk_mul_f32 v[104:105], v[104:105], v[60:61]
    v_pk_mul_f32 v[106:107], v[106:107], v[62:63]
    v_cvt_pk_bf16_f32 v32, v92, v93
    v_cvt_pk_bf16_f32 v33, v94, v95
    v_cvt_pk_bf16_f32 v34, v96, v97
    v_cvt_pk_bf16_f32 v35, v98, v99
    v_cvt_pk_bf16_f32 v36, v100, v101
    v_cvt_pk_bf16_f32 v37, v102, v103
    v_cvt_pk_bf16_f32 v38, v104, v105
    v_cvt_pk_bf16_f32 v39, v106, v107
    buffer_store_dwordx4 v[32:35], v240, s[28:31], s42 offen offset:0 sc1
    buffer_store_dwordx4 v[36:39], v240, s[28:31], s42 offen offset:1024 sc1
    v_pk_fma_f32 v[108:109], v[164:165], v[148:149], v[108:109]
    v_pk_fma_f32 v[110:111], v[166:167], v[148:149], v[110:111]
    v_pk_fma_f32 v[112:113], v[168:169], v[148:149], v[112:113]
    v_pk_fma_f32 v[114:115], v[170:171], v[148:149], v[114:115]
    v_pk_fma_f32 v[116:117], v[172:173], v[148:149], v[116:117]
    v_pk_fma_f32 v[118:119], v[174:175], v[148:149], v[118:119]
    v_pk_fma_f32 v[120:121], v[176:177], v[148:149], v[120:121]
    v_pk_fma_f32 v[122:123], v[178:179], v[148:149], v[122:123]
    v_pk_mul_f32 v[48:49], v[108:109], v[108:109]
    v_pk_mul_f32 v[50:51], v[110:111], v[110:111]
    v_pk_mul_f32 v[52:53], v[112:113], v[112:113]
    v_pk_mul_f32 v[54:55], v[114:115], v[114:115]
    v_pk_mul_f32 v[56:57], v[116:117], v[116:117]
    v_pk_mul_f32 v[58:59], v[118:119], v[118:119]
    v_pk_mul_f32 v[60:61], v[120:121], v[120:121]
    v_pk_mul_f32 v[62:63], v[122:123], v[122:123]
    v_pk_fma_f32 v[48:49], v[48:49], v[152:153], v[150:151]
    v_pk_fma_f32 v[50:51], v[50:51], v[152:153], v[150:151]
    v_pk_fma_f32 v[52:53], v[52:53], v[152:153], v[150:151]
    v_pk_fma_f32 v[54:55], v[54:55], v[152:153], v[150:151]
    v_pk_fma_f32 v[56:57], v[56:57], v[152:153], v[150:151]
    v_pk_fma_f32 v[58:59], v[58:59], v[152:153], v[150:151]
    v_pk_fma_f32 v[60:61], v[60:61], v[152:153], v[150:151]
    v_pk_fma_f32 v[62:63], v[62:63], v[152:153], v[150:151]
    v_pk_mul_f32 v[48:49], v[48:49], v[108:109]
    v_pk_mul_f32 v[50:51], v[50:51], v[110:111]
    v_pk_mul_f32 v[52:53], v[52:53], v[112:113]
    v_pk_mul_f32 v[54:55], v[54:55], v[114:115]
    v_pk_mul_f32 v[56:57], v[56:57], v[116:117]
    v_pk_mul_f32 v[58:59], v[58:59], v[118:119]
    v_pk_mul_f32 v[60:61], v[60:61], v[120:121]
    v_pk_mul_f32 v[62:63], v[62:63], v[122:123]
    v_exp_f32 v48, v48
    v_exp_f32 v49, v49
    v_exp_f32 v50, v50
    v_exp_f32 v51, v51
    v_exp_f32 v52, v52
    v_exp_f32 v53, v53
    v_exp_f32 v54, v54
    v_exp_f32 v55, v55
    v_exp_f32 v56, v56
    v_exp_f32 v57, v57
    v_exp_f32 v58, v58
    v_exp_f32 v59, v59
    v_exp_f32 v60, v60
    v_exp_f32 v61, v61
    v_exp_f32 v62, v62
    v_exp_f32 v63, v63
    v_pk_fma_f32 v[48:49], v[48:49], v[154:155], v[154:155]
    v_pk_fma_f32 v[50:51], v[50:51], v[154:155], v[154:155]
    v_pk_fma_f32 v[52:53], v[52:53], v[154:155], v[154:155]
    v_pk_fma_f32 v[54:55], v[54:55], v[154:155], v[154:155]
    v_pk_fma_f32 v[56:57], v[56:57], v[154:155], v[154:155]
    v_pk_fma_f32 v[58:59], v[58:59], v[154:155], v[154:155]
    v_pk_fma_f32 v[60:61], v[60:61], v[154:155], v[154:155]
    v_pk_fma_f32 v[62:63], v[62:63], v[154:155], v[154:155]
    v_rcp_f32 v48, v48
    v_rcp_f32 v49, v49
    v_rcp_f32 v50, v50
    v_rcp_f32 v51, v51
    v_rcp_f32 v52, v52
    v_rcp_f32 v53, v53
    v_rcp_f32 v54, v54
    v_rcp_f32 v55, v55
    v_rcp_f32 v56, v56
    v_rcp_f32 v57, v57
    v_rcp_f32 v58, v58
    v_rcp_f32 v59, v59
    v_rcp_f32 v60, v60
    v_rcp_f32 v61, v61
    v_rcp_f32 v62, v62
    v_rcp_f32 v63, v63
    v_pk_mul_f32 v[108:109], v[108:109], v[48:49]
    v_pk_mul_f32 v[110:111], v[110:111], v[50:51]
    v_pk_mul_f32 v[112:113], v[112:113], v[52:53]
    v_pk_mul_f32 v[114:115], v[114:115], v[54:55]
    v_pk_mul_f32 v[116:117], v[116:117], v[56:57]
    v_pk_mul_f32 v[118:119], v[118:119], v[58:59]
    v_pk_mul_f32 v[120:121], v[120:121], v[60:61]
    v_pk_mul_f32 v[122:123], v[122:123], v[62:63]
    v_cvt_pk_bf16_f32 v40, v108, v109
    v_cvt_pk_bf16_f32 v41, v110, v111
    v_cvt_pk_bf16_f32 v42, v112, v113
    v_cvt_pk_bf16_f32 v43, v114, v115
    v_cvt_pk_bf16_f32 v44, v116, v117
    v_cvt_pk_bf16_f32 v45, v118, v119
    v_cvt_pk_bf16_f32 v46, v120, v121
    v_cvt_pk_bf16_f32 v47, v122, v123
    buffer_store_dwordx4 v[40:43], v240, s[28:31], s43 offen offset:0 sc1
    buffer_store_dwordx4 v[44:47], v240, s[28:31], s43 offen offset:1024 sc1
    v_add_u32 v9, 4096, v240
    v_add_u32 v10, 8192, v240
    v_add_u32 v11, 12288, v240
    v_mov_b32 v8, v240
    v_mov_b32 v4, v241
    s_cmp_eq_u32 s41, 0
    s_cbranch_scc1 sw_64
    v_mov_b32 v4, v242
sw_64:
    v_xor_b32 v5, 64, v4
    s_lshl_b32 s32, s68, 2
    s_lshl_b32 s33, s41, 1
    s_add_u32 s32, s32, s33
    s_mul_i32 s32, s32, 57344
    s_mul_i32 s33, s40, 14336
    s_add_u32 s32, s32, s33
    s_add_u32 s32, s32, 11796480
    s_add_u32 s33, s32, 57344
    s_mul_i32 s36, s40, 401408
    s_mul_i32 s34, s41, 14336
    s_add_u32 s36, s36, s34
    s_add_u32 s36, s36, s66
    s_mul_i32 s35, s40, 24576
    s_add_u32 s35, s35, 57344
    s_lshl_b32 s37, s41, 11
    s_add_u32 s37, s37, s35
    s_mul_i32 s44, s41, 28672
    v_add_u32 v24, s44, v236
    v_add_u32 v20, s35, v236
    v_add_u32 v25, s44, v237
    v_add_u32 v21, s35, v237
    v_add_u32 v26, s44, v238
    v_add_u32 v22, s35, v238
    v_add_u32 v27, s44, v239
    v_add_u32 v23, s35, v239
    s_mov_b32 s24, s6
    s_and_b32 s25, s7, 0xffff
    s_mov_b32 s26, 1605632
    s_mov_b32 s27, 0x00020000
    s_mov_b32 s48, s8
    s_and_b32 s49, s9, 0xffff
    s_mov_b32 s50, 1835008
    s_mov_b32 s51, 0x00020000
    s_and_b64 s[96:97], s[96:97], 0x1ffff
    s_cbranch_scc0 spec_65
    s_mov_b64 exec, 0x1ffff
    s_mov_b32 s85, 11272192
    s_mov_b32 s93, 0
pol_66:
    buffer_load_dword v253, v245, s[28:31], s85 offen sc1
    s_add_u32 s93, s93, 1
    s_waitcnt vmcnt(0)
    v_cmp_ne_u32 vcc, s84, v253
    s_cmp_lt_u32 s93, 0x20000
    s_cselect_b64 s[94:95], vcc, 0
    s_cmp_lg_u64 s[94:95], 0
    s_cbranch_scc1 pol_66
    s_mov_b64 exec, -1
    buffer_load_dwordx4 v[204:207], v240, s[28:31], s62 offen offset:0 sc1
    buffer_load_dwordx4 v[208:211], v240, s[28:31], s62 offen offset:1024 sc1
    buffer_load_dwordx4 v[212:215], v240, s[28:31], s62 offen offset:2048 sc1
    buffer_load_dwordx4 v[216:219], v240, s[28:31], s62 offen offset:3072 sc1
    buffer_load_dwordx4 v[220:223], v240, s[28:31], s63 offen offset:0 sc1
    buffer_load_dwordx4 v[224:227], v240, s[28:31], s63 offen offset:1024 sc1
    buffer_load_dwordx4 v[228:231], v240, s[28:31], s63 offen offset:2048 sc1
    buffer_load_dword v247, v246, s[28:31], s64 offen sc1
    s_waitcnt vmcnt(0)
spec_65:
    s_waitcnt vmcnt(4)
    s_barrier
    ds_read_b64_tr_b16 v[160:161], v24 offset:0
    ds_read_b64_tr_b16 v[162:163], v24 offset:512
    ds_read_b64_tr_b16 v[164:165], v25 offset:0
    ds_read_b64_tr_b16 v[166:167], v25 offset:512
    ds_read_b64_tr_b16 v[168:169], v26 offset:0
    ds_read_b64_tr_b16 v[170:171], v26 offset:512
    ds_read_b64_tr_b16 v[172:173], v27 offset:0
    ds_read_b64_tr_b16 v[174:175], v27 offset:512
    s_waitcnt lgkmcnt(0)
    v_mfma_f32_16x16x32_bf16 v[144:147], v[160:163], v[204:207], 0
    ds_read_b64_tr_b16 v[176:177], v24 offset:4096
    ds_read_b64_tr_b16 v[178:179], v24 offset:4608
    ds_read_b64_tr_b16 v[180:181], v25 offset:4096
    ds_read_b64_tr_b16 v[182:183], v25 offset:4608
    v_mfma_f32_16x16x32_bf16 v[148:151], v[164:167], v[204:207], 0
    ds_read_b64_tr_b16 v[184:185], v26 offset:4096
    ds_read_b64_tr_b16 v[186:187], v26 offset:4608
    ds_read_b64_tr_b16 v[188:189], v27 offset:4096
    ds_read_b64_tr_b16 v[190:191], v27 offset:4608
    v_mfma_f32_16x16x32_bf16 v[152:155], v[168:171], v[204:207], 0
    v_mfma_f32_16x16x32_bf16 v[156:159], v[172:175], v[204:207], 0
    s_waitcnt lgkmcnt(0)
    v_mfma_f32_16x16x32_bf16 v[144:147], v[176:179], v[208:211], v[144:147]
    ds_read_b64_tr_b16 v[160:161], v24 offset:8192
    ds_read_b64_tr_b16 v[162:163], v24 offset:8704
    ds_read_b64_tr_b16 v[164:165], v25 offset:8192
    ds_read_b64_tr_b16 v[166:167], v25 offset:8704
    v_mfma_f32_16x16x32_bf16 v[148:151], v[180:183], v[208:211], v[148:151]
    ds_read_b64_tr_b16 v[168:169], v26 offset:8192
    ds_read_b64_tr_b16 v[170:171], v26 offset:8704
    ds_read_b64_tr_b16 v[172:173], v27 offset:8192
    ds_read_b64_tr_b16 v[174:175], v27 offset:8704
    v_mfma_f32_16x16x32_bf16 v[152:155], v[184:187], v[208:211], v[152:155]
    s_add_u32 m0, s37, 0
    s_nop 0
    buffer_load_dwordx4 v4, s[24:27], s36 offen lds
    s_add_u32 s36, s36, 7168
    v_mfma_f32_16x16x32_bf16 v[156:159], v[188:191], v[208:211], v[156:159]
    s_add_u32 m0, s37, 1024
    s_nop 0
    buffer_load_dwordx4 v5, s[24:27], s36 offen lds
    s_add_u32 s36, s36, 21504
    s_waitcnt vmcnt(2)
    s_barrier
    s_cmp_lg_u32 s19, 0
    s_cbranch_scc1 pub_67
    s_lshl_b32 s85, s2, 7
    s_add_u32 s85, s85, 11370496
    v_mov_b32 v252, 0
    v_mov_b32 v253, s84
    s_mov_b64 exec, 1
    buffer_store_dword v253, v252, s[28:31], s85 offen sc1
    s_mov_b64 exec, -1
pub_67:
    s_waitcnt lgkmcnt(0)
    v_mfma_f32_16x16x32_bf16 v[144:147], v[160:163], v[212:215], v[144:147]
    ds_read_b64_tr_b16 v[176:177], v24 offset:12288
    ds_read_b64_tr_b16 v[178:179], v24 offset:12800
    ds_read_b64_tr_b16 v[180:181], v25 offset:12288
    ds_read_b64_tr_b16 v[182:183], v25 offset:12800
    v_mfma_f32_16x16x32_bf16 v[148:151], v[164:167], v[212:215], v[148:151]
    ds_read_b64_tr_b16 v[184:185], v26 offset:12288
    ds_read_b64_tr_b16 v[186:187], v26 offset:12800
    ds_read_b64_tr_b16 v[188:189], v27 offset:12288
    ds_read_b64_tr_b16 v[190:191], v27 offset:12800
    v_mfma_f32_16x16x32_bf16 v[152:155], v[168:171], v[212:215], v[152:155]
    s_add_u32 m0, s37, 4096
    s_nop 0
    buffer_load_dwordx4 v4, s[24:27], s36 offen lds
    s_add_u32 s36, s36, 7168
    v_mfma_f32_16x16x32_bf16 v[156:159], v[172:175], v[212:215], v[156:159]
    s_add_u32 m0, s37, 5120
    s_nop 0
    buffer_load_dwordx4 v5, s[24:27], s36 offen lds
    s_add_u32 s36, s36, 21504
    s_waitcnt lgkmcnt(0)
    v_mfma_f32_16x16x32_bf16 v[144:147], v[176:179], v[216:219], v[144:147]
    ds_read_b64_tr_b16 v[160:161], v24 offset:16384
    ds_read_b64_tr_b16 v[162:163], v24 offset:16896
    ds_read_b64_tr_b16 v[164:165], v25 offset:16384
    ds_read_b64_tr_b16 v[166:167], v25 offset:16896
    v_mfma_f32_16x16x32_bf16 v[148:151], v[180:183], v[216:219], v[148:151]
    ds_read_b64_tr_b16 v[168:169], v26 offset:16384
    ds_read_b64_tr_b16 v[170:171], v26 offset:16896
    ds_read_b64_tr_b16 v[172:173], v27 offset:16384
    ds_read_b64_tr_b16 v[174:175], v27 offset:16896
    v_mfma_f32_16x16x32_bf16 v[152:155], v[184:187], v[216:219], v[152:155]
    s_add_u32 m0, s37, 8192
    s_nop 0
    buffer_load_dwordx4 v4, s[24:27], s36 offen lds
    s_add_u32 s36, s36, 7168
    v_mfma_f32_16x16x32_bf16 v[156:159], v[188:191], v[216:219], v[156:159]
    s_add_u32 m0, s37, 9216
    s_nop 0
    buffer_load_dwordx4 v5, s[24:27], s36 offen lds
    s_add_u32 s36, s36, 21504
    s_waitcnt lgkmcnt(0)
    v_mfma_f32_16x16x32_bf16 v[144:147], v[160:163], v[220:223], v[144:147]
    ds_read_b64_tr_b16 v[176:177], v24 offset:20480
    ds_read_b64_tr_b16 v[178:179], v24 offset:20992
    ds_read_b64_tr_b16 v[180:181], v25 offset:20480
    ds_read_b64_tr_b16 v[182:183], v25 offset:20992
    v_mfma_f32_16x16x32_bf16 v[148:151], v[164:167], v[220:223], v[148:151]
    ds_read_b64_tr_b16 v[184:185], v26 offset:20480
    ds_read_b64_tr_b16 v[186:187], v26 offset:20992
    ds_read_b64_tr_b16 v[188:189], v27 offset:20480
    ds_read_b64_tr_b16 v[190:191], v27 offset:20992
    v_mfma_f32_16x16x32_bf16 v[152:155], v[168:171], v[220:223], v[152:155]
    s_add_u32 m0, s37, 12288
    s_nop 0
    buffer_load_dwordx4 v4, s[24:27], s36 offen lds
    s_add_u32 s36, s36, 7168
    v_mfma_f32_16x16x32_bf16 v[156:159], v[172:175], v[220:223], v[156:159]
    s_add_u32 m0, s37, 13312
    s_nop 0
    buffer_load_dwordx4 v5, s[24:27], s36 offen lds
    s_add_u32 s36, s36, 21504
    s_waitcnt lgkmcnt(0)
    v_mfma_f32_16x16x32_bf16 v[144:147], v[176:179], v[224:227], v[144:147]
    ds_read_b64_tr_b16 v[160:161], v24 offset:24576
    ds_read_b64_tr_b16 v[162:163], v24 offset:25088
    ds_read_b64_tr_b16 v[164:165], v25 offset:24576
    ds_read_b64_tr_b16 v[166:167], v25 offset:25088
    v_mfma_f32_16x16x32_bf16 v[148:151], v[180:183], v[224:227], v[148:151]
    ds_read_b64_tr_b16 v[168:169], v26 offset:24576
    ds_read_b64_tr_b16 v[170:171], v26 offset:25088
    ds_read_b64_tr_b16 v[172:173], v27 offset:24576
    ds_read_b64_tr_b16 v[174:175], v27 offset:25088
    v_mfma_f32_16x16x32_bf16 v[152:155], v[184:187], v[224:227], v[152:155]
    s_add_u32 m0, s37, 16384
    s_nop 0
    buffer_load_dwordx4 v4, s[24:27], s36 offen lds
    s_add_u32 s36, s36, 7168
    v_mfma_f32_16x16x32_bf16 v[156:159], v[188:191], v[224:227], v[156:159]
    s_add_u32 m0, s37, 17408
    s_nop 0
    buffer_load_dwordx4 v5, s[24:27], s36 offen lds
    s_add_u32 s36, s36, 21504
    s_waitcnt lgkmcnt(0)
    v_mfma_f32_16x16x32_bf16 v[144:147], v[160:163], v[228:231], v[144:147]
    v_mfma_f32_16x16x32_bf16 v[148:151], v[164:167], v[228:231], v[148:151]
    v_mfma_f32_16x16x32_bf16 v[152:155], v[168:171], v[228:231], v[152:155]
    s_add_u32 m0, s37, 20480
    s_nop 0
    buffer_load_dwordx4 v4, s[24:27], s36 offen lds
    s_add_u32 s36, s36, 7168
    v_mfma_f32_16x16x32_bf16 v[156:159], v[172:175], v[228:231], v[156:159]
    s_add_u32 m0, s37, 21504
    s_nop 0
    buffer_load_dwordx4 v5, s[24:27], s36 offen lds
    s_add_u32 s36, s36, 21504
    s_cmp_lg_u32 s19, 0
    s_cbranch_scc1 pol_68
    s_lshr_b32 s85, s68, 1
    v_mov_b32 v232, s85
    v_mov_b32 v233, v1
    v_lshrrev_b32 v252, 2, v232
    v_lshlrev_b32 v252, 1, v252
    v_cmp_lt_u32 vcc, 6, v233
    s_nop 1
    v_addc_co_u32 v252, vcc, 0, v252, vcc
    v_cmp_lt_u32 vcc, 6, v233
    v_and_b32 v234, 3, v232
    v_mul_u32_u24 v234, 7, v234
    v_add_u32 v234, v234, v233
    v_subrev_u32 v232, 7, v234
    v_cndmask_b32 v234, v234, v232, vcc
    v_lshl_add_u32 v252, v234, 3, v252
    v_lshlrev_b32 v252, 7, v252
    v_add_u32 v252, 98304, v252
    s_mov_b64 exec, 0x3fff
    s_mov_b32 s85, 11272192
    s_mov_b32 s93, 0
pol_69:
    buffer_load_dword v253, v252, s[28:31], s85 offen sc1
    s_add_u32 s93, s93, 1
    s_waitcnt vmcnt(0)
    v_cmp_ne_u32 vcc, s84, v253
    s_cmp_lt_u32 s93, 0x20000
    s_cselect_b64 s[94:95], vcc, 0
    s_cmp_lg_u64 s[94:95], 0
    s_cbranch_scc1 pol_69
    s_mov_b64 exec, -1
pol_68:
    s_waitcnt vmcnt(0)
    s_barrier
    buffer_load_dwordx4 v[32:35], v8, s[28:31], s32 offen offset:0 sc1
    buffer_load_dwordx4 v[36:39], v8, s[28:31], s33 offen offset:0 sc1
    buffer_load_dwordx4 v[40:43], v8, s[28:31], s32 offen offset:1024 sc1
    buffer_load_dwordx4 v[44:47], v8, s[28:31], s33 offen offset:1024 sc1
    buffer_load_dwordx4 v[48:51], v8, s[28:31], s32 offen offset:2048 sc1
    buffer_load_dwordx4 v[52:55], v8, s[28:31], s33 offen offset:2048 sc1
    ds_read_b64_tr_b16 v[80:81], v20 offset:0
    ds_read_b64_tr_b16 v[82:83], v20 offset:512
    ds_read_b64_tr_b16 v[84:85], v21 offset:0
    ds_read_b64_tr_b16 v[86:87], v21 offset:512
    ds_read_b64_tr_b16 v[88:89], v22 offset:0
    ds_read_b64_tr_b16 v[90:91], v22 offset:512
    ds_read_b64_tr_b16 v[92:93], v23 offset:0
    ds_read_b64_tr_b16 v[94:95], v23 offset:512
    s_waitcnt vmcnt(4) lgkmcnt(0)
    v_mfma_f32_16x16x32_bf16 v[112:115], v[80:83], v[32:35], 0
    ds_read_b64_tr_b16 v[96:97], v20 offset:4096
    ds_read_b64_tr_b16 v[98:99], v20 offset:4608
    buffer_load_dwordx4 v[56:59], v8, s[28:31], s32 offen offset:3072 sc1
    v_mfma_f32_16x16x32_bf16 v[128:131], v[80:83], v[36:39], 0
    ds_read_b64_tr_b16 v[100:101], v21 offset:4096
    ds_read_b64_tr_b16 v[102:103], v21 offset:4608
    buffer_load_dwordx4 v[60:63], v8, s[28:31], s33 offen offset:3072 sc1
    v_mfma_f32_16x16x32_bf16 v[116:119], v[84:87], v[32:35], 0
    ds_read_b64_tr_b16 v[104:105], v22 offset:4096
    ds_read_b64_tr_b16 v[106:107], v22 offset:4608
    buffer_load_dwordx4 v[64:67], v9, s[28:31], s32 offen offset:0 sc1
    v_mfma_f32_16x16x32_bf16 v[132:135], v[84:87], v[36:39], 0
    ds_read_b64_tr_b16 v[108:109], v23 offset:4096
    ds_read_b64_tr_b16 v[110:111], v23 offset:4608
    buffer_load_dwordx4 v[68:71], v9, s[28:31], s33 offen offset:0 sc1
    v_mfma_f32_16x16x32_bf16 v[120:123], v[88:91], v[32:35], 0
    v_mfma_f32_16x16x32_bf16 v[136:139], v[88:91], v[36:39], 0
    v_mfma_f32_16x16x32_bf16 v[124:127], v[92:95], v[32:35], 0
    v_mfma_f32_16x16x32_bf16 v[140:143], v[92:95], v[36:39], 0
    s_waitcnt vmcnt(6) lgkmcnt(0)
    v_mfma_f32_16x16x32_bf16 v[112:115], v[96:99], v[40:43], v[112:115]
    ds_read_b64_tr_b16 v[80:81], v20 offset:8192
    ds_read_b64_tr_b16 v[82:83], v20 offset:8704
    buffer_load_dwordx4 v[72:75], v9, s[28:31], s32 offen offset:1024 sc1
    v_mfma_f32_16x16x32_bf16 v[128:131], v[96:99], v[44:47], v[128:131]
    ds_read_b64_tr_b16 v[84:85], v21 offset:8192
    ds_read_b64_tr_b16 v[86:87], v21 offset:8704
    buffer_load_dwordx4 v[76:79], v9, s[28:31], s33 offen offset:1024 sc1
    v_mfma_f32_16x16x32_bf16 v[116:119], v[100:103], v[40:43], v[116:119]
    ds_read_b64_tr_b16 v[88:89], v22 offset:8192
    ds_read_b64_tr_b16 v[90:91], v22 offset:8704
    buffer_load_dwordx4 v[32:35], v9, s[28:31], s32 offen offset:2048 sc1
    v_mfma_f32_16x16x32_bf16 v[132:135], v[100:103], v[44:47], v[132:135]
    ds_read_b64_tr_b16 v[92:93], v23 offset:8192
    ds_read_b64_tr_b16 v[94:95], v23 offset:8704
    buffer_load_dwordx4 v[36:39], v9, s[28:31], s33 offen offset:2048 sc1
    v_mfma_f32_16x16x32_bf16 v[120:123], v[104:107], v[40:43], v[120:123]
    v_mfma_f32_16x16x32_bf16 v[136:139], v[104:107], v[44:47], v[136:139]
    v_mfma_f32_16x16x32_bf16 v[124:127], v[108:111], v[40:43], v[124:127]
    v_mfma_f32_16x16x32_bf16 v[140:143], v[108:111], v[44:47], v[140:143]
    s_waitcnt vmcnt(8) lgkmcnt(0)
    s_barrier
    v_mfma_f32_16x16x32_bf16 v[112:115], v[80:83], v[48:51], v[112:115]
    ds_read_b64_tr_b16 v[96:97], v20 offset:12288
    ds_read_b64_tr_b16 v[98:99], v20 offset:12800
    buffer_load_dwordx4 v[40:43], v9, s[28:31], s32 offen offset:3072 sc1
    v_mfma_f32_16x16x32_bf16 v[128:131], v[80:83], v[52:55], v[128:131]
    ds_read_b64_tr_b16 v[100:101], v21 offset:12288
    ds_read_b64_tr_b16 v[102:103], v21 offset:12800
    buffer_load_dwordx4 v[44:47], v9, s[28:31], s33 offen offset:3072 sc1
    v_mfma_f32_16x16x32_bf16 v[116:119], v[84:87], v[48:51], v[116:119]
    ds_read_b64_tr_b16 v[104:105], v22 offset:12288
    ds_read_b64_tr_b16 v[106:107], v22 offset:12800
    s_add_u32 m0, s37, 0
    s_nop 0
    buffer_load_dwordx4 v4, s[24:27], s36 offen lds
    s_add_u32 s36, s36, 7168
    v_mfma_f32_16x16x32_bf16 v[132:135], v[84:87], v[52:55], v[132:135]
    ds_read_b64_tr_b16 v[108:109], v23 offset:12288
    ds_read_b64_tr_b16 v[110:111], v23 offset:12800
    s_add_u32 m0, s37, 1024
    s_nop 0
    buffer_load_dwordx4 v5, s[24:27], s36 offen lds
    s_add_u32 s36, s36, 21504
    v_mfma_f32_16x16x32_bf16 v[120:123], v[88:91], v[48:51], v[120:123]
    s_add_u32 m0, s37, 4096
    s_nop 0
    buffer_load_dwordx4 v4, s[24:27], s36 offen lds
    s_add_u32 s36, s36, 7168
    v_mfma_f32_16x16x32_bf16 v[136:139], v[88:91], v[52:55], v[136:139]
    s_add_u32 m0, s37, 5120
    s_nop 0
    buffer_load_dwordx4 v5, s[24:27], s36 offen lds
    s_add_u32 s36, s36, 21504
    v_mfma_f32_16x16x32_bf16 v[124:127], v[92:95], v[48:51], v[124:127]
    v_mfma_f32_16x16x32_bf16 v[140:143], v[92:95], v[52:55], v[140:143]
    s_waitcnt vmcnt(12) lgkmcnt(0)
    v_mfma_f32_16x16x32_bf16 v[112:115], v[96:99], v[56:59], v[112:115]
    ds_read_b64_tr_b16 v[80:81], v20 offset:16384
    ds_read_b64_tr_b16 v[82:83], v20 offset:16896
    buffer_load_dwordx4 v[48:51], v10, s[28:31], s32 offen offset:0 sc1
    v_mfma_f32_16x16x32_bf16 v[128:131], v[96:99], v[60:63], v[128:131]
    ds_read_b64_tr_b16 v[84:85], v21 offset:16384
    ds_read_b64_tr_b16 v[86:87], v21 offset:16896
    buffer_load_dwordx4 v[52:55], v10, s[28:31], s33 offen offset:0 sc1
    v_mfma_f32_16x16x32_bf16 v[116:119], v[100:103], v[56:59], v[116:119]
    ds_read_b64_tr_b16 v[88:89], v22 offset:16384
    ds_read_b64_tr_b16 v[90:91], v22 offset:16896
    s_add_u32 m0, s37, 8192
    s_nop 0
    buffer_load_dwordx4 v4, s[24:27], s36 offen lds
    s_add_u32 s36, s36, 7168
    v_mfma_f32_16x16x32_bf16 v[132:135], v[100:103], v[60:63], v[132:135]
    ds_read_b64_tr_b16 v[92:93], v23 offset:16384
    ds_read_b64_tr_b16 v[94:95], v23 offset:16896
    s_add_u32 m0, s37, 9216
    s_nop 0
    buffer_load_dwordx4 v5, s[24:27], s36 offen lds
    s_add_u32 s36, s36, 21504
    v_mfma_f32_16x16x32_bf16 v[120:123], v[104:107], v[56:59], v[120:123]
    v_mfma_f32_16x16x32_bf16 v[136:139], v[104:107], v[60:63], v[136:139]
    v_mfma_f32_16x16x32_bf16 v[124:127], v[108:111], v[56:59], v[124:127]
    v_mfma_f32_16x16x32_bf16 v[140:143], v[108:111], v[60:63], v[140:143]
    s_waitcnt vmcnt(6) lgkmcnt(0)
    s_barrier
    v_mfma_f32_16x16x32_bf16 v[112:115], v[80:83], v[64:67], v[112:115]
    ds_read_b64_tr_b16 v[96:97], v20 offset:20480
    ds_read_b64_tr_b16 v[98:99], v20 offset:20992
    buffer_load_dwordx4 v[56:59], v10, s[28:31], s32 offen offset:1024 sc1
    v_mfma_f32_16x16x32_bf16 v[128:131], v[80:83], v[68:71], v[128:131]
    ds_read_b64_tr_b16 v[100:101], v21 offset:20480
    ds_read_b64_tr_b16 v[102:103], v21 offset:20992
    buffer_load_dwordx4 v[60:63], v10, s[28:31], s33 offen offset:1024 sc1
    v_mfma_f32_16x16x32_bf16 v[116:119], v[84:87], v[64:67], v[116:119]
    ds_read_b64_tr_b16 v[104:105], v22 offset:20480
    ds_read_b64_tr_b16 v[106:107], v22 offset:20992
    s_add_u32 m0, s37, 12288
    s_nop 0
    buffer_load_dwordx4 v4, s[24:27], s36 offen lds
    s_add_u32 s36, s36, 7168
    v_mfma_f32_16x16x32_bf16 v[132:135], v[84:87], v[68:71], v[132:135]
    ds_read_b64_tr_b16 v[108:109], v23 offset:20480
    ds_read_b64_tr_b16 v[110:111], v23 offset:20992
    s_add_u32 m0, s37, 13312
    s_nop 0
    buffer_load_dwordx4 v5, s[24:27], s36 offen lds
    s_add_u32 s36, s36, 21504
    v_mfma_f32_16x16x32_bf16 v[120:123], v[88:91], v[64:67], v[120:123]
    v_mfma_f32_16x16x32_bf16 v[136:139], v[88:91], v[68:71], v[136:139]
    v_mfma_f32_16x16x32_bf16 v[124:127], v[92:95], v[64:67], v[124:127]
    v_mfma_f32_16x16x32_bf16 v[140:143], v[92:95], v[68:71], v[140:143]
    s_waitcnt vmcnt(16) lgkmcnt(0)
    v_mfma_f32_16x16x32_bf16 v[112:115], v[96:99], v[72:75], v[112:115]
    ds_read_b64_tr_b16 v[80:81], v20 offset:0
    ds_read_b64_tr_b16 v[82:83], v20 offset:512
    buffer_load_dwordx4 v[64:67], v10, s[28:31], s32 offen offset:2048 sc1
    v_mfma_f32_16x16x32_bf16 v[128:131], v[96:99], v[76:79], v[128:131]
    ds_read_b64_tr_b16 v[84:85], v21 offset:0
    ds_read_b64_tr_b16 v[86:87], v21 offset:512
    buffer_load_dwordx4 v[68:71], v10, s[28:31], s33 offen offset:2048 sc1
    v_mfma_f32_16x16x32_bf16 v[116:119], v[100:103], v[72:75], v[116:119]
    ds_read_b64_tr_b16 v[88:89], v22 offset:0
    ds_read_b64_tr_b16 v[90:91], v22 offset:512
    s_add_u32 m0, s37, 16384
    s_nop 0
    buffer_load_dwordx4 v4, s[24:27], s36 offen lds
    s_add_u32 s36, s36, 7168
    v_mfma_f32_16x16x32_bf16 v[132:135], v[100:103], v[76:79], v[132:135]
    ds_read_b64_tr_b16 v[92:93], v23 offset:0
    ds_read_b64_tr_b16 v[94:95], v23 offset:512
    s_add_u32 m0, s37, 17408
    s_nop 0
    buffer_load_dwordx4 v5, s[24:27], s36 offen lds
    s_add_u32 s36, s36, 21504
    v_mfma_f32_16x16x32_bf16 v[120:123], v[104:107], v[72:75], v[120:123]
    v_mfma_f32_16x16x32_bf16 v[136:139], v[104:107], v[76:79], v[136:139]
    v_mfma_f32_16x16x32_bf16 v[124:127], v[108:111], v[72:75], v[124:127]
    v_mfma_f32_16x16x32_bf16 v[140:143], v[108:111], v[76:79], v[140:143]
    s_waitcnt vmcnt(8) lgkmcnt(0)
    s_barrier
    v_mfma_f32_16x16x32_bf16 v[112:115], v[80:83], v[32:35], v[112:115]
    ds_read_b64_tr_b16 v[96:97], v20 offset:4096
    ds_read_b64_tr_b16 v[98:99], v20 offset:4608
    buffer_load_dwordx4 v[72:75], v10, s[28:31], s32 offen offset:3072 sc1
    v_mfma_f32_16x16x32_bf16 v[128:131], v[80:83], v[36:39], v[128:131]
    ds_read_b64_tr_b16 v[100:101], v21 offset:4096
    ds_read_b64_tr_b16 v[102:103], v21 offset:4608
    buffer_load_dwordx4 v[76:79], v10, s[28:31], s33 offen offset:3072 sc1
    v_mfma_f32_16x16x32_bf16 v[116:119], v[84:87], v[32:35], v[116:119]
    ds_read_b64_tr_b16 v[104:105], v22 offset:4096
    ds_read_b64_tr_b16 v[106:107], v22 offset:4608
    s_add_u32 m0, s37, 20480
    s_nop 0
    buffer_load_dwordx4 v4, s[24:27], s36 offen lds
    s_add_u32 s36, s36, 7168
    v_mfma_f32_16x16x32_bf16 v[132:135], v[84:87], v[36:39], v[132:135]
    ds_read_b64_tr_b16 v[108:109], v23 offset:4096
    ds_read_b64_tr_b16 v[110:111], v23 offset:4608
    s_add_u32 m0, s37, 21504
    s_nop 0
    buffer_load_dwordx4 v5, s[24:27], s36 offen lds
    s_add_u32 s36, s36, 21504
    v_mfma_f32_16x16x32_bf16 v[120:123], v[88:91], v[32:35], v[120:123]
    v_mfma_f32_16x16x32_bf16 v[136:139], v[88:91], v[36:39], v[136:139]
    v_mfma_f32_16x16x32_bf16 v[124:127], v[92:95], v[32:35], v[124:127]
    v_mfma_f32_16x16x32_bf16 v[140:143], v[92:95], v[36:39], v[140:143]
    s_waitcnt vmcnt(20) lgkmcnt(0)
    v_mfma_f32_16x16x32_bf16 v[112:115], v[96:99], v[40:43], v[112:115]
    ds_read_b64_tr_b16 v[80:81], v20 offset:8192
    ds_read_b64_tr_b16 v[82:83], v20 offset:8704
    buffer_load_dwordx4 v[32:35], v11, s[28:31], s32 offen offset:0 sc1
    v_mfma_f32_16x16x32_bf16 v[128:131], v[96:99], v[44:47], v[128:131]
    ds_read_b64_tr_b16 v[84:85], v21 offset:8192
    ds_read_b64_tr_b16 v[86:87], v21 offset:8704
    buffer_load_dwordx4 v[36:39], v11, s[28:31], s33 offen offset:0 sc1
    v_mfma_f32_16x16x32_bf16 v[116:119], v[100:103], v[40:43], v[116:119]
    ds_read_b64_tr_b16 v[88:89], v22 offset:8192
    ds_read_b64_tr_b16 v[90:91], v22 offset:8704
    s_add_u32 m0, s37, 0
    s_nop 0
    buffer_load_dwordx4 v4, s[24:27], s36 offen lds
    s_add_u32 s36, s36, 7168
    v_mfma_f32_16x16x32_bf16 v[132:135], v[100:103], v[44:47], v[132:135]
    ds_read_b64_tr_b16 v[92:93], v23 offset:8192
    ds_read_b64_tr_b16 v[94:95], v23 offset:8704
    s_add_u32 m0, s37, 1024
    s_nop 0
    buffer_load_dwordx4 v5, s[24:27], s36 offen lds
    s_add_u32 s36, s36, 21504
    v_mfma_f32_16x16x32_bf16 v[120:123], v[104:107], v[40:43], v[120:123]
    v_mfma_f32_16x16x32_bf16 v[136:139], v[104:107], v[44:47], v[136:139]
    v_mfma_f32_16x16x32_bf16 v[124:127], v[108:111], v[40:43], v[124:127]
    v_mfma_f32_16x16x32_bf16 v[140:143], v[108:111], v[44:47], v[140:143]
    s_waitcnt vmcnt(8) lgkmcnt(0)
    s_barrier
    v_mfma_f32_16x16x32_bf16 v[112:115], v[80:83], v[48:51], v[112:115]
    ds_read_b64_tr_b16 v[96:97], v20 offset:12288
    ds_read_b64_tr_b16 v[98:99], v20 offset:12800
    buffer_load_dwordx4 v[40:43], v11, s[28:31], s32 offen offset:1024 sc1
    v_mfma_f32_16x16x32_bf16 v[128:131], v[80:83], v[52:55], v[128:131]
    ds_read_b64_tr_b16 v[100:101], v21 offset:12288
    ds_read_b64_tr_b16 v[102:103], v21 offset:12800
    buffer_load_dwordx4 v[44:47], v11, s[28:31], s33 offen offset:1024 sc1
    v_mfma_f32_16x16x32_bf16 v[116:119], v[84:87], v[48:51], v[116:119]
    ds_read_b64_tr_b16 v[104:105], v22 offset:12288
    ds_read_b64_tr_b16 v[106:107], v22 offset:12800
    s_add_u32 m0, s37, 4096
    s_nop 0
    buffer_load_dwordx4 v4, s[24:27], s36 offen lds
    s_add_u32 s36, s36, 7168
    v_mfma_f32_16x16x32_bf16 v[132:135], v[84:87], v[52:55], v[132:135]
    ds_read_b64_tr_b16 v[108:109], v23 offset:12288
    ds_read_b64_tr_b16 v[110:111], v23 offset:12800
    s_add_u32 m0, s37, 5120
    s_nop 0
    buffer_load_dwordx4 v5, s[24:27], s36 offen lds
    s_add_u32 s36, s36, 21504
    v_mfma_f32_16x16x32_bf16 v[120:123], v[88:91], v[48:51], v[120:123]
    v_mfma_f32_16x16x32_bf16 v[136:139], v[88:91], v[52:55], v[136:139]
    v_mfma_f32_16x16x32_bf16 v[124:127], v[92:95], v[48:51], v[124:127]
    v_mfma_f32_16x16x32_bf16 v[140:143], v[92:95], v[52:55], v[140:143]
    s_waitcnt vmcnt(18) lgkmcnt(0)
    v_mfma_f32_16x16x32_bf16 v[112:115], v[96:99], v[56:59], v[112:115]
    ds_read_b64_tr_b16 v[80:81], v20 offset:16384
    ds_read_b64_tr_b16 v[82:83], v20 offset:16896
    v_mfma_f32_16x16x32_bf16 v[128:131], v[96:99], v[60:63], v[128:131]
    ds_read_b64_tr_b16 v[84:85], v21 offset:16384
    ds_read_b64_tr_b16 v[86:87], v21 offset:16896
    v_mfma_f32_16x16x32_bf16 v[116:119], v[100:103], v[56:59], v[116:119]
    ds_read_b64_tr_b16 v[88:89], v22 offset:16384
    ds_read_b64_tr_b16 v[90:91], v22 offset:16896
    v_mfma_f32_16x16x32_bf16 v[132:135], v[100:103], v[60:63], v[132:135]
    ds_read_b64_tr_b16 v[92:93], v23 offset:16384
    ds_read_b64_tr_b16 v[94:95], v23 offset:16896
    v_mfma_f32_16x16x32_bf16 v[120:123], v[104:107], v[56:59], v[120:123]
    v_mfma_f32_16x16x32_bf16 v[136:139], v[104:107], v[60:63], v[136:139]
    v_mfma_f32_16x16x32_bf16 v[124:127], v[108:111], v[56:59], v[124:127]
    v_mfma_f32_16x16x32_bf16 v[140:143], v[108:111], v[60:63], v[140:143]
    s_waitcnt vmcnt(4) lgkmcnt(0)
    s_barrier
    v_mfma_f32_16x16x32_bf16 v[112:115], v[80:83], v[64:67], v[112:115]
    ds_read_b64_tr_b16 v[96:97], v20 offset:20480
    ds_read_b64_tr_b16 v[98:99], v20 offset:20992
    v_mfma_f32_16x16x32_bf16 v[128:131], v[80:83], v[68:71], v[128:131]
    ds_read_b64_tr_b16 v[100:101], v21 offset:20480
    ds_read_b64_tr_b16 v[102:103], v21 offset:20992
    v_mfma_f32_16x16x32_bf16 v[116:119], v[84:87], v[64:67], v[116:119]
    ds_read_b64_tr_b16 v[104:105], v22 offset:20480
    ds_read_b64_tr_b16 v[106:107], v22 offset:20992
    v_mfma_f32_16x16x32_bf16 v[132:135], v[84:87], v[68:71], v[132:135]
    ds_read_b64_tr_b16 v[108:109], v23 offset:20480
    ds_read_b64_tr_b16 v[110:111], v23 offset:20992
    v_mfma_f32_16x16x32_bf16 v[120:123], v[88:91], v[64:67], v[120:123]
    v_mfma_f32_16x16x32_bf16 v[136:139], v[88:91], v[68:71], v[136:139]
    v_mfma_f32_16x16x32_bf16 v[124:127], v[92:95], v[64:67], v[124:127]
    v_mfma_f32_16x16x32_bf16 v[140:143], v[92:95], v[68:71], v[140:143]
    s_waitcnt vmcnt(10) lgkmcnt(0)
    v_mfma_f32_16x16x32_bf16 v[112:115], v[96:99], v[72:75], v[112:115]
    ds_read_b64_tr_b16 v[80:81], v20 offset:0
    ds_read_b64_tr_b16 v[82:83], v20 offset:512
    v_mfma_f32_16x16x32_bf16 v[128:131], v[96:99], v[76:79], v[128:131]
    ds_read_b64_tr_b16 v[84:85], v21 offset:0
    ds_read_b64_tr_b16 v[86:87], v21 offset:512
    v_mfma_f32_16x16x32_bf16 v[116:119], v[100:103], v[72:75], v[116:119]
    ds_read_b64_tr_b16 v[88:89], v22 offset:0
    ds_read_b64_tr_b16 v[90:91], v22 offset:512
    v_mfma_f32_16x16x32_bf16 v[132:135], v[100:103], v[76:79], v[132:135]
    ds_read_b64_tr_b16 v[92:93], v23 offset:0
    ds_read_b64_tr_b16 v[94:95], v23 offset:512
    v_mfma_f32_16x16x32_bf16 v[120:123], v[104:107], v[72:75], v[120:123]
    v_mfma_f32_16x16x32_bf16 v[136:139], v[104:107], v[76:79], v[136:139]
    v_mfma_f32_16x16x32_bf16 v[124:127], v[108:111], v[72:75], v[124:127]
    v_mfma_f32_16x16x32_bf16 v[140:143], v[108:111], v[76:79], v[140:143]
    s_waitcnt vmcnt(0) lgkmcnt(0)
    s_barrier
    v_mfma_f32_16x16x32_bf16 v[112:115], v[80:83], v[32:35], v[112:115]
    ds_read_b64_tr_b16 v[96:97], v20 offset:4096
    ds_read_b64_tr_b16 v[98:99], v20 offset:4608
    v_mfma_f32_16x16x32_bf16 v[128:131], v[80:83], v[36:39], v[128:131]
    ds_read_b64_tr_b16 v[100:101], v21 offset:4096
    ds_read_b64_tr_b16 v[102:103], v21 offset:4608
    v_mfma_f32_16x16x32_bf16 v[116:119], v[84:87], v[32:35], v[116:119]
    ds_read_b64_tr_b16 v[104:105], v22 offset:4096
    ds_read_b64_tr_b16 v[106:107], v22 offset:4608
    v_mfma_f32_16x16x32_bf16 v[132:135], v[84:87], v[36:39], v[132:135]
    ds_read_b64_tr_b16 v[108:109], v23 offset:4096
    ds_read_b64_tr_b16 v[110:111], v23 offset:4608
    v_mfma_f32_16x16x32_bf16 v[120:123], v[88:91], v[32:35], v[120:123]
    v_mfma_f32_16x16x32_bf16 v[136:139], v[88:91], v[36:39], v[136:139]
    v_mfma_f32_16x16x32_bf16 v[124:127], v[92:95], v[32:35], v[124:127]
    v_mfma_f32_16x16x32_bf16 v[140:143], v[92:95], v[36:39], v[140:143]
    s_waitcnt vmcnt(2) lgkmcnt(0)
    v_mfma_f32_16x16x32_bf16 v[112:115], v[96:99], v[40:43], v[112:115]
    v_mfma_f32_16x16x32_bf16 v[128:131], v[96:99], v[44:47], v[128:131]
    v_mfma_f32_16x16x32_bf16 v[116:119], v[100:103], v[40:43], v[116:119]
    v_mfma_f32_16x16x32_bf16 v[132:135], v[100:103], v[44:47], v[132:135]
    v_mfma_f32_16x16x32_bf16 v[120:123], v[104:107], v[40:43], v[120:123]
    v_mfma_f32_16x16x32_bf16 v[136:139], v[104:107], v[44:47], v[136:139]
    v_mfma_f32_16x16x32_bf16 v[124:127], v[108:111], v[40:43], v[124:127]
    v_mfma_f32_16x16x32_bf16 v[140:143], v[108:111], v[44:47], v[140:143]
    s_lshl_b32 s52, s40, 14
    s_lshl_b32 s53, s41, 13
    s_add_u32 s52, s52, s53
    v_add_u32 v12, s52, v8
    s_lshl_b32 s52, s41, 14
    s_lshl_b32 s53, s40, 12
    s_add_u32 s52, s52, s53
    s_add_u32 s52, s52, 65536
    v_add_u32 v13, s52, v8
    s_barrier
    ds_write_b128 v13, v[144:147] offset:0
    ds_write_b128 v13, v[148:151] offset:1024
    ds_write_b128 v13, v[152:155] offset:2048
    ds_write_b128 v13, v[156:159] offset:3072
    ds_write_b128 v12, v[112:115] offset:0
    ds_write_b128 v12, v[116:119] offset:1024
    ds_write_b128 v12, v[120:123] offset:2048
    ds_write_b128 v12, v[124:127] offset:3072
    ds_write_b128 v12, v[128:131] offset:4096
    ds_write_b128 v12, v[132:135] offset:5120
    ds_write_b128 v12, v[136:139] offset:6144
    ds_write_b128 v12, v[140:143] offset:7168
    s_lshl_b32 s52, s40, 12
    s_lshl_b32 s53, s41, 11
    s_add_u32 s52, s52, s53
    v_add_u32 v12, s52, v8
    v_add_u32 v13, 65536, v12
    v_lshlrev_b32 v204, 16, v248
    v_and_b32 v205, 0xffff0000, v248
    v_lshlrev_b32 v206, 16, v249
    v_and_b32 v207, 0xffff0000, v249
    v_lshlrev_b32 v208, 16, v250
    v_and_b32 v209, 0xffff0000, v250
    v_lshlrev_b32 v210, 16, v251
    v_and_b32 v211, 0xffff0000, v251
    v_sub_f32 v19, 1.0, v247
    v_cvt_pk_bf16_f32 v19, 0, v19
    v_mul_u32_u24 v14, 896, v244
    v_lshrrev_b32 v16, 1, v243
    v_xor_b32 v15, 8, v16
    v_add_u32 v15, v15, v14
    v_add_u32 v14, v16, v14
    s_lshl_b32 s53, s41, 6
    s_add_u32 s52, s66, s53
    s_waitcnt lgkmcnt(0)
    s_barrier
    ds_read_b128 v[32:35], v12 offset:0
    ds_read_b128 v[36:39], v12 offset:1024
    ds_read_b128 v[40:43], v12 offset:16384
    ds_read_b128 v[44:47], v12 offset:17408
    ds_read_b128 v[48:51], v12 offset:32768
    ds_read_b128 v[52:55], v12 offset:33792
    ds_read_b128 v[56:59], v12 offset:49152
    ds_read_b128 v[60:63], v12 offset:50176
    ds_read_b128 v[64:67], v13 offset:0
    ds_read_b128 v[68:71], v13 offset:1024
    ds_read_b128 v[72:75], v13 offset:16384
    ds_read_b128 v[76:79], v13 offset:17408
    s_waitcnt lgkmcnt(4)
    v_add_f32 v32, v32, v40
    v_add_f32 v48, v48, v56
    v_add_f32 v33, v33, v41
    v_add_f32 v49, v49, v57
    v_add_f32 v34, v34, v42
    v_add_f32 v50, v50, v58
    v_add_f32 v35, v35, v43
    v_add_f32 v51, v51, v59
    v_add_f32 v36, v36, v44
    v_add_f32 v52, v52, v60
    v_add_f32 v37, v37, v45
    v_add_f32 v53, v53, v61
    v_add_f32 v38, v38, v46
    v_add_f32 v54, v54, v62
    v_add_f32 v39, v39, v47
    v_add_f32 v55, v55, v63
    v_add_f32 v32, v32, v48
    v_add_f32 v33, v33, v49
    v_add_f32 v34, v34, v50
    v_add_f32 v35, v35, v51
    v_add_f32 v36, v36, v52
    v_add_f32 v37, v37, v53
    v_add_f32 v38, v38, v54
    v_add_f32 v39, v39, v55
    v_add_f32 v32, v32, v204
    v_add_f32 v33, v33, v205
    v_add_f32 v34, v34, v206
    v_add_f32 v35, v35, v207
    v_add_f32 v36, v36, v208
    v_add_f32 v37, v37, v209
    v_add_f32 v38, v38, v210
    v_add_f32 v39, v39, v211
    v_mul_f32 v32, v19, v32
    v_mul_f32 v33, v19, v33
    v_mul_f32 v34, v19, v34
    v_mul_f32 v35, v19, v35
    v_mul_f32 v36, v19, v36
    v_mul_f32 v37, v19, v37
    v_mul_f32 v38, v19, v38
    v_mul_f32 v39, v19, v39
    s_waitcnt lgkmcnt(0)
    v_add_f32 v64, v64, v72
    v_add_f32 v65, v65, v73
    v_add_f32 v66, v66, v74
    v_add_f32 v67, v67, v75
    v_add_f32 v68, v68, v76
    v_add_f32 v69, v69, v77
    v_add_f32 v70, v70, v78
    v_add_f32 v71, v71, v79
    v_fmac_f32 v32, v247, v64
    v_fmac_f32 v33, v247, v65
    v_fmac_f32 v34, v247, v66
    v_fmac_f32 v35, v247, v67
    v_fmac_f32 v36, v247, v68
    v_fmac_f32 v37, v247, v69
    v_fmac_f32 v38, v247, v70
    v_fmac_f32 v39, v247, v71
    v_cvt_pk_bf16_f32 v204, v32, v33
    v_cvt_pk_bf16_f32 v205, v34, v35
    v_cvt_pk_bf16_f32 v206, v36, v37
    v_cvt_pk_bf16_f32 v207, v38, v39
    buffer_store_dwordx2 v[204:205], v14, s[48:51], s52 offen
    buffer_store_dwordx2 v[206:207], v15, s[48:51], s52 offen
k_end:
    s_endpgm
    s_nop 0
    s_nop 0
    s_nop 0
    s_nop 0
    s_nop 0
    s_nop 0
    s_nop 0
    s_nop 0
    s_nop 0
    s_nop 0
    s_nop 0
    s_nop 0
    s_nop 0
    s_nop 0
    s_nop 0
    s_nop 0
    s_nop 0
    s_nop 0
    s_nop 0
    s_nop 0
    s_nop 0
    s_nop 0
    s_nop 0
    s_nop 0
    s_nop 0
    s_nop 0
    s_nop 0
    s_nop 0
    s_nop 0
    s_nop 0
    s_nop 0
    s_nop 0
    s_nop 0
    s_nop 0
    s_nop 0
    s_nop 0
    s_nop 0
    s_nop 0
    s_nop 0
    s_nop 0
    s_nop 0
    s_nop 0
    s_nop 0
    s_nop 0
    s_nop 0
    s_nop 0
    s_nop 0
    s_nop 0
    s_nop 0
    s_nop 0
    s_nop 0
    s_nop 0
    s_nop 0
    s_nop 0
    s_nop 0
    s_nop 0
    s_nop 0
    s_nop 0
    s_nop 0
    s_nop 0
    s_nop 0
    s_nop 0
    s_nop 0
    s_nop 0
    s_nop 0
    s_nop 0
    s_nop 0
    s_nop 0
    s_nop 0
    s_nop 0
    s_nop 0
    s_nop 0
    s_nop 0
    s_nop 0
    s_nop 0
    s_nop 0
    s_nop 0
    s_nop 0
    s_nop 0
    s_nop 0
    s_nop 0
    s_nop 0
    s_nop 0
    s_nop 0
    s_nop 0
    s_nop 0
    s_nop 0
    s_nop 0
    s_nop 0
    s_nop 0
    s_nop 0
    s_nop 0
    s_nop 0
    s_nop 0
    s_nop 0
    s_nop 0
    s_nop 0
    s_nop 0
    s_nop 0
    s_nop 0
    s_nop 0
    s_nop 0
    s_nop 0
    s_nop 0
    s_nop 0
    s_nop 0
    s_nop 0
    s_nop 0
    s_nop 0
    s_nop 0
    s_nop 0
    s_nop 0
    s_nop 0
    s_nop 0
    s_nop 0
    s_nop 0
    s_nop 0
    s_nop 0
    s_nop 0
    s_nop 0
    s_nop 0
    s_nop 0
    s_nop 0
    s_nop 0
    s_nop 0
    s_nop 0
    s_nop 0
    s_nop 0
    s_nop 0
    s_nop 0
    s_nop 0
    s_nop 0
    s_nop 0
    s_nop 0
    s_nop 0
    s_nop 0
    s_nop 0
    s_nop 0
    s_nop 0
    s_nop 0
    s_nop 0
    s_nop 0
    s_nop 0
    s_nop 0
    s_nop 0
    s_nop 0
    s_nop 0
    s_nop 0
    s_nop 0
    s_nop 0
    s_nop 0
    s_nop 0
    s_nop 0
    s_nop 0
    s_nop 0
    s_nop 0
    s_nop 0
    s_nop 0
    s_nop 0
    s_nop 0
    s_nop 0
    s_nop 0
    s_nop 0
    s_nop 0
    s_nop 0
    s_nop 0
    s_nop 0
    s_nop 0
    s_nop 0
    s_nop 0
    s_nop 0
    s_nop 0
    s_nop 0
    s_nop 0
    s_nop 0
    s_nop 0
    s_nop 0
    s_nop 0
    s_nop 0
    s_nop 0
    s_nop 0
    s_nop 0
    s_nop 0
    s_nop 0
    s_nop 0
    s_nop 0
    s_nop 0
    s_nop 0
    s_nop 0
    s_nop 0
    s_nop 0
    s_nop 0
    s_nop 0
    s_nop 0
    s_nop 0
    s_nop 0
    s_nop 0
    s_nop 0
    s_nop 0
    s_nop 0
    s_nop 0
    s_nop 0
    s_nop 0
    s_nop 0
    s_nop 0
    s_nop 0
    s_nop 0
    s_nop 0
    s_nop 0
    s_nop 0
    s_nop 0
    s_nop 0
    s_nop 0
    s_nop 0
    s_nop 0
    s_nop 0
    s_nop 0
    s_nop 0
    s_nop 0
    s_nop 0
    s_nop 0
    s_nop 0
    s_nop 0
    s_nop 0
    s_nop 0
    s_nop 0
    s_nop 0
    s_nop 0
    s_nop 0
    s_nop 0
    s_nop 0
    s_nop 0
    s_nop 0
    s_nop 0
    s_nop 0
    s_nop 0
    s_nop 0
    s_nop 0
    s_nop 0
    s_nop 0
    s_nop 0
    s_nop 0
    s_nop 0
    s_nop 0
    s_nop 0
    s_nop 0
    s_nop 0
    s_nop 0
    s_nop 0
    s_nop 0
    s_nop 0
    s_nop 0
    s_nop 0
    s_nop 0
    s_nop 0
    s_nop 0
k_codeend:
    s_nop 0
    s_nop 0
    s_nop 0
    s_nop 0
    s_nop 0
    s_nop 0
    s_nop 0
    s_nop 0
    s_nop 0
    s_nop 0
    s_nop 0
    s_nop 0
    s_nop 0
    s_nop 0
    s_nop 0
    s_nop 0
    s_nop 0
    s_nop 0
    s_nop 0
    s_nop 0
    s_nop 0
    s_nop 0
    s_nop 0
    s_nop 0
    s_nop 0
    s_nop 0
    s_nop 0
    s_nop 0
    s_nop 0
    s_nop 0
    s_nop 0
    s_nop 0
    s_nop 0
    s_nop 0
    s_nop 0
    s_nop 0
    s_nop 0
    s_nop 0
    s_nop 0
    s_nop 0
    s_nop 0
    s_nop 0
    s_nop 0
    s_nop 0
    s_nop 0
    s_nop 0
    s_nop 0
    s_nop 0
    s_nop 0
    s_nop 0
    s_nop 0
    s_nop 0
    s_nop 0
    s_nop 0
    s_nop 0
    s_nop 0
    s_nop 0
    s_nop 0
    s_nop 0
    s_nop 0
    s_nop 0
    s_nop 0
    s_nop 0
    s_nop 0
    s_nop 0
    s_nop 0
    s_nop 0
    s_nop 0
    s_nop 0
    s_nop 0
    s_nop 0
    s_nop 0
    s_nop 0
    s_nop 0
    s_nop 0
    s_nop 0
    s_nop 0
    s_nop 0
    s_nop 0
    s_nop 0
    s_nop 0
    s_nop 0
    s_nop 0
    s_nop 0
    s_nop 0
    s_nop 0
    s_nop 0
    s_nop 0
    s_nop 0
    s_nop 0
    s_nop 0
    s_nop 0
    s_nop 0
    s_nop 0
    s_nop 0
    s_nop 0
    s_nop 0
    s_nop 0
    s_nop 0
    s_nop 0
    s_nop 0
    s_nop 0
    s_nop 0
    s_nop 0
    s_nop 0
    s_nop 0
    s_nop 0
    s_nop 0
    s_nop 0
    s_nop 0
    s_nop 0
    s_nop 0
    s_nop 0
    s_nop 0
    s_nop 0
    s_nop 0
    s_nop 0
    s_nop 0
    s_nop 0
    s_nop 0
    s_nop 0
    s_nop 0
    s_nop 0
    s_nop 0
    s_nop 0
    s_nop 0
    s_nop 0
    s_nop 0
    s_nop 0
    s_nop 0
    s_nop 0
    s_nop 0
    s_nop 0
    s_nop 0
    s_nop 0
    s_nop 0
    s_nop 0
    s_nop 0
    s_nop 0
    s_nop 0
    s_nop 0
    s_nop 0
    s_nop 0
    s_nop 0
    s_nop 0
    s_nop 0
    s_nop 0
    s_nop 0
    s_nop 0
    s_nop 0
    s_nop 0
    s_nop 0
    s_nop 0
    s_nop 0
    s_nop 0
    s_nop 0
    s_nop 0
    s_nop 0
    s_nop 0
    s_nop 0
    s_nop 0
    s_nop 0
    s_nop 0
    s_nop 0
    s_nop 0
    s_nop 0
    s_nop 0
    s_nop 0
    s_nop 0
    s_nop 0
    s_nop 0
    s_nop 0
    s_nop 0
    s_nop 0
    s_nop 0
    s_nop 0
    s_nop 0
    s_nop 0
    s_nop 0
    s_nop 0
    s_nop 0
    s_nop 0
    s_nop 0
    s_nop 0
    s_nop 0
    s_nop 0
    s_nop 0
    s_nop 0
    s_nop 0
    s_nop 0
    s_nop 0
    s_nop 0
    s_nop 0
    s_nop 0
    s_nop 0
    s_nop 0
    s_nop 0
    s_nop 0
    s_nop 0
    s_nop 0
    s_nop 0
    s_nop 0
    s_nop 0
    s_nop 0
    s_nop 0
    s_nop 0
    s_nop 0
    s_nop 0
    s_nop 0
    s_nop 0
    s_nop 0
    s_nop 0
    s_nop 0
    s_nop 0
    s_nop 0
    s_nop 0
    s_nop 0
    s_nop 0
    s_nop 0
    s_nop 0
    s_nop 0
    s_nop 0
    s_nop 0
    s_nop 0
    s_nop 0
    s_nop 0
    s_nop 0
    s_nop 0
    s_nop 0
    s_nop 0
    s_nop 0
    s_nop 0
    s_nop 0
    s_nop 0
    s_nop 0
    s_nop 0
    s_nop 0
    s_nop 0
    s_nop 0
    s_nop 0
    s_nop 0
    s_nop 0
    s_nop 0
    s_nop 0
    s_nop 0
    s_nop 0
    s_nop 0
    s_nop 0
    s_nop 0
    s_nop 0
    s_nop 0
    s_nop 0
    s_nop 0
    s_nop 0
    s_nop 0
    s_nop 0
    s_endpgm
.section .rodata,"a"
.p2align 6
.amdhsa_kernel gated_mix__sliding_block__mixer_s_mlp__prompt_kernel
  .amdhsa_next_free_vgpr 256
  .amdhsa_next_free_sgpr 102
  .amdhsa_accum_offset 256
  .amdhsa_group_segment_fixed_size 0
  .amdhsa_kernarg_size 96
  .amdhsa_user_sgpr_count 2
  .amdhsa_user_sgpr_kernarg_segment_ptr 1
  .amdhsa_system_sgpr_workgroup_id_x 1
.end_amdhsa_kernel
```
